```python
import torch

def _softmax(x, axis=-1):
    return torch.softmax(x, dim=axis)
def _gelu(x):
    return torch.nn.functional.gelu(x, approximate="tanh")
def _silu(x):
    return torch.nn.functional.silu(x)
def _sigmoid(x):
    return torch.sigmoid(x)
def _layernorm(x, axis=-1, eps=1e-5):
    m = x.mean(dim=axis, keepdim=True)
    v = x.var(dim=axis, keepdim=True, unbiased=False)
    return (x - m) / torch.sqrt(v + eps)
def _scatter_add(tgt, idx, src, axis=0):
    return tgt.clone().index_add_(axis, idx, src)
def _segment_sum(src, seg, n):
    out = torch.zeros((n,) + src.shape[1:], dtype=src.dtype)
    return out.index_add_(0, seg, src)
def _pad(x, pw):
    flat = tuple(v for pair in reversed(pw) for v in pair)
    return torch.nn.functional.pad(x, flat)

kernel_name = 'gated_mix__gqa_block_cached__glu_gated_geglu__decode'

def setup_inputs():

    _w = (lambda a: (lambda t: t.to(torch.bfloat16) if t.is_floating_point() else t)(torch.as_tensor(a)))
    def _A_setup():
        B, Sq, D = 2, 1, 576
        Hq, Hkv, Sk, Dh = 32, 16, 32768, 128
        assert Hq % Hkv == 0, (Hq, Hkv)
        return {
            "x": _w((lambda *s: torch.randn(*s, dtype=torch.bfloat16) * 0.05)(B, Sq, D)),
            "k_cache": _w((lambda *s: torch.randn(*s, dtype=torch.bfloat16) * 6.4)(B, Hkv, Sk, Dh)),
            "v_cache": _w((lambda *s: torch.randn(*s, dtype=torch.bfloat16) * 0.05)(B, Hkv, Sk, Dh)),
            "wq": _w((lambda *s: torch.randn(*s, dtype=torch.bfloat16) * 6.4)(D, Hq * Dh) * (D ** -0.5)),
            "wo": _w((lambda *s: torch.randn(*s, dtype=torch.bfloat16) * 0.05)(Hq * Dh, D) * ((Hq * Dh) ** -0.5)),
        }
    _A_in = _A_setup()

    def _B_setup():
        B, S, Dm, Df = 2, 1, 576, 4608
        return {
            "x": _w((lambda *s: torch.randn(*s, dtype=torch.bfloat16) * 0.05)(B, S, Dm)),
            "w_gate": _w((lambda *s: torch.randn(*s, dtype=torch.bfloat16) * 0.4)(Dm, Df) * (Dm ** -0.5)),
            "w_up": _w((lambda *s: torch.randn(*s, dtype=torch.bfloat16) * 0.4)(Dm, Df) * (Dm ** -0.5)),
            "w_down": _w((lambda *s: torch.randn(*s, dtype=torch.bfloat16) * 0.4)(Df, Dm) * (Df ** -0.5)),
        }
    _B_in = _B_setup()

    return {
        "A_x": _A_in["x"],
        "A_k_cache": _A_in["k_cache"],
        "A_v_cache": _A_in["v_cache"],
        "A_wq": _A_in["wq"],
        "A_wo": _A_in["wo"],
        "B_x": _B_in["x"],
        "B_w_gate": _B_in["w_gate"],
        "B_w_up": _B_in["w_up"],
        "B_w_down": _B_in["w_down"],
        "gate_w": _w((lambda *s: torch.randn(*s, dtype=torch.bfloat16) * 0.05)(576) * 16.0),
    }

def reference(A_x, A_k_cache, A_v_cache, A_wq, A_wo, B_x, B_w_gate, B_w_up, B_w_down, gate_w):
    def _A_ref(x, k_cache, v_cache, wq, wo):
        B, Sq, D = x.shape
        Hq, Dh = 32, 128
        Hkv = k_cache.shape[1]
        rep = Hq // Hkv
        q = (lambda x, *d: x.permute(*d))((x @ wq).reshape(B, Sq, Hq, Dh), 0, 2, 1, 3)
        k = (lambda x, n, axis: torch.repeat_interleave(x, n, dim=axis))(k_cache, rep, axis=1)
        v = (lambda x, n, axis: torch.repeat_interleave(x, n, dim=axis))(v_cache, rep, axis=1)
        scores = torch.einsum("bhqd,bhkd->bhqk", q, k) * (Dh ** -0.5)
        p = _softmax(scores, axis=-1)
        o = torch.einsum("bhqk,bhkd->bhqd", p, v)
        return (lambda x, *d: x.permute(*d))(o, 0, 2, 1, 3).reshape(B, Sq, Hq * Dh) @ wo

    def _B_ref(x, w_gate, w_up, w_down):
        g = torch.einsum("bsd,df->bsf", x, w_gate)
        u = torch.einsum("bsd,df->bsf", x, w_up)
        h = _gelu(g) * u
        return torch.einsum("bsf,fd->bsd", h, w_down)

    x = A_x
    g = _sigmoid((x * gate_w).sum(-1, keepdims=True))
    a = _A_ref(x, A_k_cache, A_v_cache, A_wq, A_wo)
    b = _B_ref(x, B_w_gate, B_w_up, B_w_down)
    return g * a + (1 - g) * b
```

```asm
; @launch kernel=gmix_a_kernel grid=(345,1,1) block=(256,1,1) lds=4096
; @launch kernel=gmix_b_kernel grid=(256,1,1) block=(512,1,1) lds=8320
; @launch kernel=gmix_c_kernel grid=(256,1,1) block=(320,1,1) lds=64
.amdgcn_target "amdgcn-amd-amdhsa--gfx950"
.text
.globl gmix_a_kernel
.p2align 8
.type gmix_a_kernel,@function
gmix_a_kernel:
    s_cmp_ge_u32 s2, 345
    s_cbranch_scc1 gmix_a_kernel_end
    s_load_dwordx2 s[24:25], s[0:1], 0
    s_load_dwordx2 s[26:27], s[0:1], 96
    s_load_dwordx2 s[28:29], s[0:1], 24
    s_load_dwordx4 s[32:35], s[0:1], 48
    v_and_b32 v1, 63, v0
    v_lshrrev_b32 v2, 6, v0
    s_nop 0
    v_readfirstlane_b32 s16, v2
    s_waitcnt lgkmcnt(0)
    s_mov_b32 s4, s26
    s_and_b32 s5, s27, 0xffff
    s_mov_b32 s6, 1048576
    s_mov_b32 s7, 0x00020000
    s_mov_b32 s8, s24
    s_and_b32 s9, s25, 0xffff
    s_mov_b32 s10, 2304
    s_mov_b32 s11, 0x00020000
    s_cmp_eq_u32 s2, 344
    s_cbranch_scc1 gmix_a_kernel_misc
    s_cmp_lt_u32 s2, 128
    s_cbranch_scc1 gmix_a_kernel_q
    s_sub_u32 s17, s2, 128
    s_cmp_ge_u32 s17, 108
    s_cselect_b32 s30, s34, s32
    s_cselect_b32 s31, s35, s33
    s_cselect_b32 s18, 108, 0
    s_cselect_b32 s23, 3, 0
    s_sub_u32 s17, s17, s18
    s_mov_b32 s12, s30
    s_and_b32 s13, s31, 0xffff
    s_mov_b32 s14, 5308416
    s_mov_b32 s15, 0x00020000
    s_mul_hi_u32 s22, s17, 0x55555556
    s_mul_i32 s18, s22, 3
    s_sub_u32 s18, s17, s18
    s_add_u32 s23, s23, s18
    s_mul_i32 s23, s23, 36864
    s_add_u32 s23, s23, 0xc0000
    s_mul_i32 s21, s18, 192
    s_mul_i32 s18, s16, 48
    s_add_u32 s21, s21, s18
    s_mov_b32 s20, 9216
    s_mov_b32 s19, 4608
    s_branch gmix_a_kernel_gemv
gmix_a_kernel_q:
    s_mov_b32 s12, s28
    s_and_b32 s13, s29, 0xffff
    s_mov_b32 s14, 4718592
    s_mov_b32 s15, 0x00020000
    s_lshr_b32 s22, s2, 2
    s_and_b32 s18, s2, 3
    s_mul_i32 s23, s18, 32768
    s_add_u32 s23, s23, 0xa0000
    s_mul_i32 s21, s18, 144
    s_mul_i32 s18, s16, 36
    s_add_u32 s21, s21, s18
    s_mov_b32 s20, 8192
    s_mov_b32 s19, 4096
gmix_a_kernel_gemv:
    v_and_b32 v2, 15, v1
    v_lshrrev_b32 v3, 4, v1
    v_mul_lo_u32 v5, v3, s20
    v_lshl_add_u32 v5, v2, 4, v5
    v_lshrrev_b32 v6, 3, v2
    v_mul_u32_u24 v6, 1152, v6
    v_lshl_add_u32 v6, v3, 1, v6
    s_lshl_b32 s17, s21, 1
    v_add_u32 v6, s17, v6
    buffer_load_ushort v26, v6, s[8:11], 0 offen offset:0
    buffer_load_ushort v27, v6, s[8:11], 0 offen offset:8
    buffer_load_ushort v28, v6, s[8:11], 0 offen offset:16
    buffer_load_ushort v29, v6, s[8:11], 0 offen offset:24
    buffer_load_ushort v30, v6, s[8:11], 0 offen offset:32
    buffer_load_ushort v31, v6, s[8:11], 0 offen offset:40
    buffer_load_ushort v32, v6, s[8:11], 0 offen offset:48
    buffer_load_ushort v33, v6, s[8:11], 0 offen offset:56
    buffer_load_ushort v34, v6, s[8:11], 0 offen offset:64
    buffer_load_ushort v35, v6, s[8:11], 0 offen offset:72
    buffer_load_ushort v36, v6, s[8:11], 0 offen offset:80
    buffer_load_ushort v37, v6, s[8:11], 0 offen offset:88
    s_mul_i32 s17, s21, s20
    s_lshl_b32 s18, s22, 8
    s_add_u32 s17, s17, s18
    s_lshl_b32 s18, s20, 2
    buffer_load_dwordx4 v[38:41], v5, s[12:15], s17 offen
    s_add_u32 s17, s17, s18
    buffer_load_dwordx4 v[42:45], v5, s[12:15], s17 offen
    s_add_u32 s17, s17, s18
    buffer_load_dwordx4 v[46:49], v5, s[12:15], s17 offen
    s_add_u32 s17, s17, s18
    buffer_load_dwordx4 v[50:53], v5, s[12:15], s17 offen
    s_add_u32 s17, s17, s18
    buffer_load_dwordx4 v[54:57], v5, s[12:15], s17 offen
    s_add_u32 s17, s17, s18
    buffer_load_dwordx4 v[58:61], v5, s[12:15], s17 offen
    s_add_u32 s17, s17, s18
    buffer_load_dwordx4 v[62:65], v5, s[12:15], s17 offen
    s_add_u32 s17, s17, s18
    buffer_load_dwordx4 v[66:69], v5, s[12:15], s17 offen
    s_add_u32 s17, s17, s18
    buffer_load_dwordx4 v[70:73], v5, s[12:15], s17 offen
    s_add_u32 s17, s17, s18
    buffer_load_dwordx4 v[74:77], v5, s[12:15], s17 offen
    s_add_u32 s17, s17, s18
    buffer_load_dwordx4 v[78:81], v5, s[12:15], s17 offen
    s_add_u32 s17, s17, s18
    buffer_load_dwordx4 v[82:85], v5, s[12:15], s17 offen
    s_add_u32 s17, s17, s18
    v_and_b32 v2, 7, v1
    v_lshrrev_b32 v11, 1, v2
    v_and_b32 v10, 1, v2
    v_mov_b32 v9, 0xffff
    v_mov_b32 v8, 0xffff0000
    v_cmp_eq_u32 vcc, 1, v10
    s_nop 1
    v_cndmask_b32 v10, v9, v8, vcc
    v_mov_b32 v8, v11
    v_mov_b32 v9, v10
    v_cmp_eq_u32 vcc, 3, v8
    s_nop 1
    v_cndmask_b32 v11, 0, v9, vcc
    v_cmp_eq_u32 vcc, 2, v8
    s_nop 1
    v_cndmask_b32 v10, 0, v9, vcc
    v_cmp_eq_u32 vcc, 1, v8
    v_mov_b32 v12, v9
    s_nop 0
    v_cndmask_b32 v9, 0, v12, vcc
    v_cmp_eq_u32 vcc, 0, v8
    s_nop 1
    v_cndmask_b32 v8, 0, v12, vcc
    s_cmp_eq_u32 s20, 8192
    s_cselect_b32 s17, 0, -1
    s_waitcnt vmcnt(0)
    v_lshl_or_b32 v2, v26, 16, v26
    v_and_b32 v18, v2, v8
    v_and_b32 v19, v2, v9
    v_and_b32 v20, v2, v10
    v_and_b32 v21, v2, v11
    s_nop 1
    v_mfma_f32_16x16x32_bf16 v[14:17], v[38:41], v[18:21], 0
    v_lshl_or_b32 v2, v27, 16, v27
    v_and_b32 v22, v2, v8
    v_and_b32 v23, v2, v9
    v_and_b32 v24, v2, v10
    v_and_b32 v25, v2, v11
    s_nop 1
    v_mfma_f32_16x16x32_bf16 v[14:17], v[42:45], v[22:25], v[14:17]
    v_lshl_or_b32 v2, v28, 16, v28
    v_and_b32 v18, v2, v8
    v_and_b32 v19, v2, v9
    v_and_b32 v20, v2, v10
    v_and_b32 v21, v2, v11
    s_nop 1
    v_mfma_f32_16x16x32_bf16 v[14:17], v[46:49], v[18:21], v[14:17]
    v_lshl_or_b32 v2, v29, 16, v29
    v_and_b32 v22, v2, v8
    v_and_b32 v23, v2, v9
    v_and_b32 v24, v2, v10
    v_and_b32 v25, v2, v11
    s_nop 1
    v_mfma_f32_16x16x32_bf16 v[14:17], v[50:53], v[22:25], v[14:17]
    v_lshl_or_b32 v2, v30, 16, v30
    v_and_b32 v18, v2, v8
    v_and_b32 v19, v2, v9
    v_and_b32 v20, v2, v10
    v_and_b32 v21, v2, v11
    s_nop 1
    v_mfma_f32_16x16x32_bf16 v[14:17], v[54:57], v[18:21], v[14:17]
    v_lshl_or_b32 v2, v31, 16, v31
    v_and_b32 v22, v2, v8
    v_and_b32 v23, v2, v9
    v_and_b32 v24, v2, v10
    v_and_b32 v25, v2, v11
    s_nop 1
    v_mfma_f32_16x16x32_bf16 v[14:17], v[58:61], v[22:25], v[14:17]
    v_lshl_or_b32 v2, v32, 16, v32
    v_and_b32 v18, v2, v8
    v_and_b32 v19, v2, v9
    v_and_b32 v20, v2, v10
    v_and_b32 v21, v2, v11
    s_nop 1
    v_mfma_f32_16x16x32_bf16 v[14:17], v[62:65], v[18:21], v[14:17]
    v_lshl_or_b32 v2, v33, 16, v33
    v_and_b32 v22, v2, v8
    v_and_b32 v23, v2, v9
    v_and_b32 v24, v2, v10
    v_and_b32 v25, v2, v11
    s_nop 1
    v_mfma_f32_16x16x32_bf16 v[14:17], v[66:69], v[22:25], v[14:17]
    v_lshl_or_b32 v2, v34, 16, v34
    v_and_b32 v18, v2, v8
    v_and_b32 v19, v2, v9
    v_and_b32 v20, v2, v10
    v_and_b32 v21, v2, v11
    s_nop 1
    v_mfma_f32_16x16x32_bf16 v[14:17], v[70:73], v[18:21], v[14:17]
    v_and_b32 v35, s17, v35
    v_lshl_or_b32 v2, v35, 16, v35
    v_and_b32 v22, v2, v8
    v_and_b32 v23, v2, v9
    v_and_b32 v24, v2, v10
    v_and_b32 v25, v2, v11
    s_nop 1
    v_mfma_f32_16x16x32_bf16 v[14:17], v[74:77], v[22:25], v[14:17]
    v_and_b32 v36, s17, v36
    v_lshl_or_b32 v2, v36, 16, v36
    v_and_b32 v18, v2, v8
    v_and_b32 v19, v2, v9
    v_and_b32 v20, v2, v10
    v_and_b32 v21, v2, v11
    s_nop 1
    v_mfma_f32_16x16x32_bf16 v[14:17], v[78:81], v[18:21], v[14:17]
    v_and_b32 v37, s17, v37
    v_lshl_or_b32 v2, v37, 16, v37
    v_and_b32 v22, v2, v8
    v_and_b32 v23, v2, v9
    v_and_b32 v24, v2, v10
    v_and_b32 v25, v2, v11
    s_nop 1
    v_mfma_f32_16x16x32_bf16 v[14:17], v[82:85], v[22:25], v[14:17]
    s_nop 7
    s_lshl_b32 s17, s16, 10
    v_lshl_add_u32 v2, v1, 4, s17
    ds_write_b128 v2, v[14:17]
    s_waitcnt lgkmcnt(0)
    s_barrier
    v_lshlrev_b32 v2, 2, v0
    ds_read_b32 v26, v2 offset:0
    ds_read_b32 v27, v2 offset:1024
    ds_read_b32 v28, v2 offset:2048
    ds_read_b32 v29, v2 offset:3072
    s_waitcnt lgkmcnt(0)
    v_add_f32 v26, v26, v27
    v_add_f32 v26, v26, v28
    v_add_f32 v26, v26, v29
    v_lshrrev_b32 v2, 2, v0
    v_and_b32 v3, 3, v0
    v_lshrrev_b32 v4, 4, v2
    v_lshl_add_u32 v4, v4, 2, v3
    v_lshlrev_b32 v4, 3, v4
    v_and_b32 v3, 7, v2
    v_add_u32 v4, v4, v3
    v_bfe_u32 v3, v2, 3, 1
    v_mul_lo_u32 v3, v3, s19
    v_add_u32 v4, v4, v3
    s_lshl_b32 s17, s22, 7
    v_add_u32 v4, s17, v4
    v_lshlrev_b32 v4, 2, v4
    buffer_store_dword v26, v4, s[4:7], s23 offen
    s_branch gmix_a_kernel_done
gmix_a_kernel_misc:
    v_lshlrev_b32 v2, 4, v0
    v_add_u32 v2, 0x20000, v2
    v_mov_b32 v14, 0
    v_mov_b32 v15, 0
    v_mov_b32 v16, 0
    v_mov_b32 v17, 0
    buffer_store_dwordx4 v[14:17], v2, s[4:7], 0 offen
    v_add_u32 v2, 4096, v2
    buffer_store_dwordx4 v[14:17], v2, s[4:7], 0 offen
    v_add_u32 v2, 4096, v2
    buffer_store_dwordx4 v[14:17], v2, s[4:7], 0 offen
    v_add_u32 v2, 4096, v2
    buffer_store_dwordx4 v[14:17], v2, s[4:7], 0 offen
    v_add_u32 v2, 4096, v2
    buffer_store_dwordx4 v[14:17], v2, s[4:7], 0 offen
    v_add_u32 v2, 4096, v2
    buffer_store_dwordx4 v[14:17], v2, s[4:7], 0 offen
    v_add_u32 v2, 4096, v2
    buffer_store_dwordx4 v[14:17], v2, s[4:7], 0 offen
    v_add_u32 v2, 4096, v2
    buffer_store_dwordx4 v[14:17], v2, s[4:7], 0 offen
    v_add_u32 v2, 4096, v2
    buffer_store_dwordx4 v[14:17], v2, s[4:7], 0 offen
    v_add_u32 v2, 4096, v2
    buffer_store_dwordx4 v[14:17], v2, s[4:7], 0 offen
    v_add_u32 v2, 4096, v2
    s_cmp_lg_u32 s16, 0
    s_cbranch_scc1 gmix_a_kernel_done
    s_load_dwordx2 s[30:31], s[0:1], 72
    s_waitcnt lgkmcnt(0)
    s_mov_b32 s12, s30
    s_and_b32 s13, s31, 0xffff
    s_mov_b32 s14, 1152
    s_mov_b32 s15, 0x00020000
    v_mul_u32_u24 v2, 18, v1
    buffer_load_ushort v38, v2, s[12:15], 0 offen offset:0
    buffer_load_ushort v48, v2, s[8:11], 0 offen offset:0
    buffer_load_ushort v58, v2, s[8:11], 0 offen offset:1152
    buffer_load_ushort v39, v2, s[12:15], 0 offen offset:2
    buffer_load_ushort v49, v2, s[8:11], 0 offen offset:2
    buffer_load_ushort v59, v2, s[8:11], 0 offen offset:1154
    buffer_load_ushort v40, v2, s[12:15], 0 offen offset:4
    buffer_load_ushort v50, v2, s[8:11], 0 offen offset:4
    buffer_load_ushort v60, v2, s[8:11], 0 offen offset:1156
    buffer_load_ushort v41, v2, s[12:15], 0 offen offset:6
    buffer_load_ushort v51, v2, s[8:11], 0 offen offset:6
    buffer_load_ushort v61, v2, s[8:11], 0 offen offset:1158
    buffer_load_ushort v42, v2, s[12:15], 0 offen offset:8
    buffer_load_ushort v52, v2, s[8:11], 0 offen offset:8
    buffer_load_ushort v62, v2, s[8:11], 0 offen offset:1160
    buffer_load_ushort v43, v2, s[12:15], 0 offen offset:10
    buffer_load_ushort v53, v2, s[8:11], 0 offen offset:10
    buffer_load_ushort v63, v2, s[8:11], 0 offen offset:1162
    buffer_load_ushort v44, v2, s[12:15], 0 offen offset:12
    buffer_load_ushort v54, v2, s[8:11], 0 offen offset:12
    buffer_load_ushort v64, v2, s[8:11], 0 offen offset:1164
    buffer_load_ushort v45, v2, s[12:15], 0 offen offset:14
    buffer_load_ushort v55, v2, s[8:11], 0 offen offset:14
    buffer_load_ushort v65, v2, s[8:11], 0 offen offset:1166
    buffer_load_ushort v46, v2, s[12:15], 0 offen offset:16
    buffer_load_ushort v56, v2, s[8:11], 0 offen offset:16
    buffer_load_ushort v66, v2, s[8:11], 0 offen offset:1168
    s_waitcnt vmcnt(0)
    v_mov_b32 v14, 0
    v_mov_b32 v15, 0
    v_lshlrev_b32 v38, 16, v38
    v_lshlrev_b32 v48, 16, v48
    v_lshlrev_b32 v58, 16, v58
    v_fma_f32 v14, v38, v48, v14
    v_fma_f32 v15, v38, v58, v15
    v_lshlrev_b32 v39, 16, v39
    v_lshlrev_b32 v49, 16, v49
    v_lshlrev_b32 v59, 16, v59
    v_fma_f32 v14, v39, v49, v14
    v_fma_f32 v15, v39, v59, v15
    v_lshlrev_b32 v40, 16, v40
    v_lshlrev_b32 v50, 16, v50
    v_lshlrev_b32 v60, 16, v60
    v_fma_f32 v14, v40, v50, v14
    v_fma_f32 v15, v40, v60, v15
    v_lshlrev_b32 v41, 16, v41
    v_lshlrev_b32 v51, 16, v51
    v_lshlrev_b32 v61, 16, v61
    v_fma_f32 v14, v41, v51, v14
    v_fma_f32 v15, v41, v61, v15
    v_lshlrev_b32 v42, 16, v42
    v_lshlrev_b32 v52, 16, v52
    v_lshlrev_b32 v62, 16, v62
    v_fma_f32 v14, v42, v52, v14
    v_fma_f32 v15, v42, v62, v15
    v_lshlrev_b32 v43, 16, v43
    v_lshlrev_b32 v53, 16, v53
    v_lshlrev_b32 v63, 16, v63
    v_fma_f32 v14, v43, v53, v14
    v_fma_f32 v15, v43, v63, v15
    v_lshlrev_b32 v44, 16, v44
    v_lshlrev_b32 v54, 16, v54
    v_lshlrev_b32 v64, 16, v64
    v_fma_f32 v14, v44, v54, v14
    v_fma_f32 v15, v44, v64, v15
    v_lshlrev_b32 v45, 16, v45
    v_lshlrev_b32 v55, 16, v55
    v_lshlrev_b32 v65, 16, v65
    v_fma_f32 v14, v45, v55, v14
    v_fma_f32 v15, v45, v65, v15
    v_lshlrev_b32 v46, 16, v46
    v_lshlrev_b32 v56, 16, v56
    v_lshlrev_b32 v66, 16, v66
    v_fma_f32 v14, v46, v56, v14
    v_fma_f32 v15, v46, v66, v15
    v_xor_b32 v2, 32, v1
    v_lshlrev_b32 v2, 2, v2
    ds_bpermute_b32 v3, v2, v14
    ds_bpermute_b32 v4, v2, v15
    s_waitcnt lgkmcnt(0)
    v_add_f32 v14, v14, v3
    v_add_f32 v15, v15, v4
    v_xor_b32 v2, 16, v1
    v_lshlrev_b32 v2, 2, v2
    ds_bpermute_b32 v3, v2, v14
    ds_bpermute_b32 v4, v2, v15
    s_waitcnt lgkmcnt(0)
    v_add_f32 v14, v14, v3
    v_add_f32 v15, v15, v4
    v_xor_b32 v2, 8, v1
    v_lshlrev_b32 v2, 2, v2
    ds_bpermute_b32 v3, v2, v14
    ds_bpermute_b32 v4, v2, v15
    s_waitcnt lgkmcnt(0)
    v_add_f32 v14, v14, v3
    v_add_f32 v15, v15, v4
    v_xor_b32 v2, 4, v1
    v_lshlrev_b32 v2, 2, v2
    ds_bpermute_b32 v3, v2, v14
    ds_bpermute_b32 v4, v2, v15
    s_waitcnt lgkmcnt(0)
    v_add_f32 v14, v14, v3
    v_add_f32 v15, v15, v4
    v_xor_b32 v2, 2, v1
    v_lshlrev_b32 v2, 2, v2
    ds_bpermute_b32 v3, v2, v14
    ds_bpermute_b32 v4, v2, v15
    s_waitcnt lgkmcnt(0)
    v_add_f32 v14, v14, v3
    v_add_f32 v15, v15, v4
    v_xor_b32 v2, 1, v1
    v_lshlrev_b32 v2, 2, v2
    ds_bpermute_b32 v3, v2, v14
    ds_bpermute_b32 v4, v2, v15
    s_waitcnt lgkmcnt(0)
    v_add_f32 v14, v14, v3
    v_add_f32 v15, v15, v4
    s_mov_b32 s17, 0xbfb8aa3b
    v_mul_f32 v14, s17, v14
    v_exp_f32 v14, v14
    s_nop 0
    v_add_f32 v14, 1.0, v14
    v_rcp_f32 v14, v14
    v_mul_f32 v15, s17, v15
    v_exp_f32 v15, v15
    s_nop 0
    v_add_f32 v15, 1.0, v15
    v_rcp_f32 v15, v15
    v_mov_b32 v2, 0x10000
    buffer_store_dwordx2 v[14:15], v2, s[4:7], 0 offen
gmix_a_kernel_done:
    s_waitcnt vmcnt(0)
gmix_a_kernel_end:
    s_endpgm
.globl gmix_b_kernel
.p2align 8
.type gmix_b_kernel,@function
gmix_b_kernel:
    s_cmp_ge_u32 s2, 256
    s_cbranch_scc1 gmix_b_kernel_end
    s_load_dwordx4 s[24:27], s[0:1], 8
    s_load_dwordx2 s[28:29], s[0:1], 96
    v_and_b32 v1, 63, v0
    v_lshrrev_b32 v13, 6, v0
    s_nop 0
    v_readfirstlane_b32 s19, v13
    s_waitcnt lgkmcnt(0)
    s_mov_b32 s4, s24
    s_and_b32 s5, s25, 0xffff
    s_mov_b32 s6, 268435456
    s_mov_b32 s7, 0x00020000
    s_mov_b32 s8, s26
    s_and_b32 s9, s27, 0xffff
    s_mov_b32 s10, 268435456
    s_mov_b32 s11, 0x00020000
    s_mov_b32 s12, s28
    s_and_b32 s13, s29, 0xffff
    s_mov_b32 s14, 1048576
    s_mov_b32 s15, 0x00020000
    s_and_b32 s21, s2, 7
    s_lshl_b32 s21, s21, 1
    s_bfe_u32 s22, s2, 0x10003
    s_add_u32 s21, s21, s22
    s_bfe_u32 s22, s2, 0x10004
    s_lshl_b32 s22, s22, 4
    s_add_u32 s21, s21, s22
    s_lshr_b32 s22, s2, 5
    s_mul_i32 s22, s22, 8
    s_add_u32 s22, s22, s19
    s_mul_i32 s22, s22, 131072
    s_lshl_b32 s16, s21, 23
    s_add_u32 s16, s16, s22
    s_mov_b32 s20, 0x3e0293ee
    v_and_b32 v13, 15, v1
    v_lshrrev_b32 v14, 4, v1
    v_lshlrev_b32 v2, 8, v13
    v_lshl_add_u32 v2, v14, 4, v2
    v_lshlrev_b32 v3, 10, v14
    v_lshl_add_u32 v3, v13, 4, v3
    v_lshrrev_b32 v9, 3, v13
    s_lshl_b32 s21, s21, 1
    v_add_u32 v9, s21, v9
    v_lshlrev_b32 v9, 9, v9
    v_lshl_add_u32 v9, v14, 5, v9
    s_mov_b32 s22, 0xa0000
    buffer_load_dwordx4 v[60:63], v9, s[12:15], s22 offen offset:0
    buffer_load_dwordx4 v[64:67], v9, s[12:15], s22 offen offset:16
    s_mov_b32 s22, 0xa8000
    buffer_load_dwordx4 v[68:71], v9, s[12:15], s22 offen offset:0
    buffer_load_dwordx4 v[72:75], v9, s[12:15], s22 offen offset:16
    s_mov_b32 s22, 0xb0000
    buffer_load_dwordx4 v[76:79], v9, s[12:15], s22 offen offset:0
    buffer_load_dwordx4 v[80:83], v9, s[12:15], s22 offen offset:16
    s_mov_b32 s22, 0xb8000
    buffer_load_dwordx4 v[84:87], v9, s[12:15], s22 offen offset:0
    buffer_load_dwordx4 v[88:91], v9, s[12:15], s22 offen offset:16
    s_waitcnt vmcnt(0)
    v_add_f32 v60, v60, v68
    v_add_f32 v60, v60, v76
    v_add_f32 v60, v60, v84
    v_add_f32 v61, v61, v69
    v_add_f32 v61, v61, v77
    v_add_f32 v61, v61, v85
    v_add_f32 v62, v62, v70
    v_add_f32 v62, v62, v78
    v_add_f32 v62, v62, v86
    v_add_f32 v63, v63, v71
    v_add_f32 v63, v63, v79
    v_add_f32 v63, v63, v87
    v_add_f32 v64, v64, v72
    v_add_f32 v64, v64, v80
    v_add_f32 v64, v64, v88
    v_add_f32 v65, v65, v73
    v_add_f32 v65, v65, v81
    v_add_f32 v65, v65, v89
    v_add_f32 v66, v66, v74
    v_add_f32 v66, v66, v82
    v_add_f32 v66, v66, v90
    v_add_f32 v67, v67, v75
    v_add_f32 v67, v67, v83
    v_add_f32 v67, v67, v91
    v_cvt_pk_bf16_f32 v20, v60, v61
    v_cvt_pk_bf16_f32 v21, v62, v63
    v_cvt_pk_bf16_f32 v22, v64, v65
    v_cvt_pk_bf16_f32 v23, v66, v67
    s_mov_b32 s22, 0xa0000
    buffer_load_dwordx4 v[60:63], v9, s[12:15], s22 offen offset:128
    buffer_load_dwordx4 v[64:67], v9, s[12:15], s22 offen offset:144
    s_mov_b32 s22, 0xa8000
    buffer_load_dwordx4 v[68:71], v9, s[12:15], s22 offen offset:128
    buffer_load_dwordx4 v[72:75], v9, s[12:15], s22 offen offset:144
    s_mov_b32 s22, 0xb0000
    buffer_load_dwordx4 v[76:79], v9, s[12:15], s22 offen offset:128
    buffer_load_dwordx4 v[80:83], v9, s[12:15], s22 offen offset:144
    s_mov_b32 s22, 0xb8000
    buffer_load_dwordx4 v[84:87], v9, s[12:15], s22 offen offset:128
    buffer_load_dwordx4 v[88:91], v9, s[12:15], s22 offen offset:144
    s_waitcnt vmcnt(0)
    v_add_f32 v60, v60, v68
    v_add_f32 v60, v60, v76
    v_add_f32 v60, v60, v84
    v_add_f32 v61, v61, v69
    v_add_f32 v61, v61, v77
    v_add_f32 v61, v61, v85
    v_add_f32 v62, v62, v70
    v_add_f32 v62, v62, v78
    v_add_f32 v62, v62, v86
    v_add_f32 v63, v63, v71
    v_add_f32 v63, v63, v79
    v_add_f32 v63, v63, v87
    v_add_f32 v64, v64, v72
    v_add_f32 v64, v64, v80
    v_add_f32 v64, v64, v88
    v_add_f32 v65, v65, v73
    v_add_f32 v65, v65, v81
    v_add_f32 v65, v65, v89
    v_add_f32 v66, v66, v74
    v_add_f32 v66, v66, v82
    v_add_f32 v66, v66, v90
    v_add_f32 v67, v67, v75
    v_add_f32 v67, v67, v83
    v_add_f32 v67, v67, v91
    v_cvt_pk_bf16_f32 v24, v60, v61
    v_cvt_pk_bf16_f32 v25, v62, v63
    v_cvt_pk_bf16_f32 v26, v64, v65
    v_cvt_pk_bf16_f32 v27, v66, v67
    s_mov_b32 s22, 0xa0000
    buffer_load_dwordx4 v[60:63], v9, s[12:15], s22 offen offset:256
    buffer_load_dwordx4 v[64:67], v9, s[12:15], s22 offen offset:272
    s_mov_b32 s22, 0xa8000
    buffer_load_dwordx4 v[68:71], v9, s[12:15], s22 offen offset:256
    buffer_load_dwordx4 v[72:75], v9, s[12:15], s22 offen offset:272
    s_mov_b32 s22, 0xb0000
    buffer_load_dwordx4 v[76:79], v9, s[12:15], s22 offen offset:256
    buffer_load_dwordx4 v[80:83], v9, s[12:15], s22 offen offset:272
    s_mov_b32 s22, 0xb8000
    buffer_load_dwordx4 v[84:87], v9, s[12:15], s22 offen offset:256
    buffer_load_dwordx4 v[88:91], v9, s[12:15], s22 offen offset:272
    s_waitcnt vmcnt(0)
    v_add_f32 v60, v60, v68
    v_add_f32 v60, v60, v76
    v_add_f32 v60, v60, v84
    v_add_f32 v61, v61, v69
    v_add_f32 v61, v61, v77
    v_add_f32 v61, v61, v85
    v_add_f32 v62, v62, v70
    v_add_f32 v62, v62, v78
    v_add_f32 v62, v62, v86
    v_add_f32 v63, v63, v71
    v_add_f32 v63, v63, v79
    v_add_f32 v63, v63, v87
    v_add_f32 v64, v64, v72
    v_add_f32 v64, v64, v80
    v_add_f32 v64, v64, v88
    v_add_f32 v65, v65, v73
    v_add_f32 v65, v65, v81
    v_add_f32 v65, v65, v89
    v_add_f32 v66, v66, v74
    v_add_f32 v66, v66, v82
    v_add_f32 v66, v66, v90
    v_add_f32 v67, v67, v75
    v_add_f32 v67, v67, v83
    v_add_f32 v67, v67, v91
    v_cvt_pk_bf16_f32 v28, v60, v61
    v_cvt_pk_bf16_f32 v29, v62, v63
    v_cvt_pk_bf16_f32 v30, v64, v65
    v_cvt_pk_bf16_f32 v31, v66, v67
    s_mov_b32 s22, 0xa0000
    buffer_load_dwordx4 v[60:63], v9, s[12:15], s22 offen offset:384
    buffer_load_dwordx4 v[64:67], v9, s[12:15], s22 offen offset:400
    s_mov_b32 s22, 0xa8000
    buffer_load_dwordx4 v[68:71], v9, s[12:15], s22 offen offset:384
    buffer_load_dwordx4 v[72:75], v9, s[12:15], s22 offen offset:400
    s_mov_b32 s22, 0xb0000
    buffer_load_dwordx4 v[76:79], v9, s[12:15], s22 offen offset:384
    buffer_load_dwordx4 v[80:83], v9, s[12:15], s22 offen offset:400
    s_mov_b32 s22, 0xb8000
    buffer_load_dwordx4 v[84:87], v9, s[12:15], s22 offen offset:384
    buffer_load_dwordx4 v[88:91], v9, s[12:15], s22 offen offset:400
    s_waitcnt vmcnt(0)
    v_add_f32 v60, v60, v68
    v_add_f32 v60, v60, v76
    v_add_f32 v60, v60, v84
    v_add_f32 v61, v61, v69
    v_add_f32 v61, v61, v77
    v_add_f32 v61, v61, v85
    v_add_f32 v62, v62, v70
    v_add_f32 v62, v62, v78
    v_add_f32 v62, v62, v86
    v_add_f32 v63, v63, v71
    v_add_f32 v63, v63, v79
    v_add_f32 v63, v63, v87
    v_add_f32 v64, v64, v72
    v_add_f32 v64, v64, v80
    v_add_f32 v64, v64, v88
    v_add_f32 v65, v65, v73
    v_add_f32 v65, v65, v81
    v_add_f32 v65, v65, v89
    v_add_f32 v66, v66, v74
    v_add_f32 v66, v66, v82
    v_add_f32 v66, v66, v90
    v_add_f32 v67, v67, v75
    v_add_f32 v67, v67, v83
    v_add_f32 v67, v67, v91
    v_cvt_pk_bf16_f32 v32, v60, v61
    v_cvt_pk_bf16_f32 v33, v62, v63
    v_cvt_pk_bf16_f32 v34, v64, v65
    v_cvt_pk_bf16_f32 v35, v66, v67
    v_and_b32 v13, 7, v1
    v_lshrrev_b32 v7, 1, v13
    v_and_b32 v6, 1, v13
    v_mov_b32 v5, 0xffff
    v_mov_b32 v4, 0xffff0000
    v_cmp_eq_u32 vcc, 1, v6
    s_nop 1
    v_cndmask_b32 v6, v5, v4, vcc
    v_mov_b32 v4, v7
    v_mov_b32 v5, v6
    v_cmp_eq_u32 vcc, 3, v4
    s_nop 1
    v_cndmask_b32 v7, 0, v5, vcc
    v_cmp_eq_u32 vcc, 2, v4
    s_nop 1
    v_cndmask_b32 v6, 0, v5, vcc
    v_cmp_eq_u32 vcc, 1, v4
    v_mov_b32 v8, v5
    s_nop 0
    v_cndmask_b32 v5, 0, v8, vcc
    v_cmp_eq_u32 vcc, 0, v4
    s_nop 1
    v_cndmask_b32 v4, 0, v8, vcc
    v_mov_b32 v9, 0xff800000
    v_mov_b32 v10, 0
    v_mov_b32 v16, 0
    v_mov_b32 v17, 0
    v_mov_b32 v18, 0
    v_mov_b32 v19, 0
    s_add_u32 s17, s16, 0
    buffer_load_dwordx4 v[60:63], v2, s[4:7], s16 offen offset:0 nt
    buffer_load_dwordx4 v[64:67], v2, s[4:7], s16 offen offset:64 nt
    buffer_load_dwordx4 v[68:71], v2, s[4:7], s16 offen offset:128 nt
    buffer_load_dwordx4 v[72:75], v2, s[4:7], s16 offen offset:192 nt
    s_add_u32 s17, s16, 4096
    buffer_load_dwordx4 v[76:79], v2, s[4:7], s17 offen offset:0 nt
    buffer_load_dwordx4 v[80:83], v2, s[4:7], s17 offen offset:64 nt
    buffer_load_dwordx4 v[84:87], v2, s[4:7], s17 offen offset:128 nt
    buffer_load_dwordx4 v[88:91], v2, s[4:7], s17 offen offset:192 nt
    buffer_load_dwordx4 v[124:127], v3, s[8:11], s16 offen offset:0 nt
    buffer_load_dwordx4 v[128:131], v3, s[8:11], s16 offen offset:256 nt
    buffer_load_dwordx4 v[132:135], v3, s[8:11], s16 offen offset:512 nt
    buffer_load_dwordx4 v[136:139], v3, s[8:11], s16 offen offset:768 nt
    s_add_u32 s17, s16, 4096
    buffer_load_dwordx4 v[140:143], v3, s[8:11], s17 offen offset:0 nt
    buffer_load_dwordx4 v[144:147], v3, s[8:11], s17 offen offset:256 nt
    buffer_load_dwordx4 v[148:151], v3, s[8:11], s17 offen offset:512 nt
    buffer_load_dwordx4 v[152:155], v3, s[8:11], s17 offen offset:768 nt
    s_add_u32 s16, s16, 8192
    s_mov_b32 s18, 7
gmix_b_kernel_loop:
    s_add_u32 s17, s16, 0
    buffer_load_dwordx4 v[92:95], v2, s[4:7], s16 offen offset:0 nt
    buffer_load_dwordx4 v[96:99], v2, s[4:7], s16 offen offset:64 nt
    buffer_load_dwordx4 v[100:103], v2, s[4:7], s16 offen offset:128 nt
    buffer_load_dwordx4 v[104:107], v2, s[4:7], s16 offen offset:192 nt
    s_add_u32 s17, s16, 4096
    buffer_load_dwordx4 v[108:111], v2, s[4:7], s17 offen offset:0 nt
    buffer_load_dwordx4 v[112:115], v2, s[4:7], s17 offen offset:64 nt
    buffer_load_dwordx4 v[116:119], v2, s[4:7], s17 offen offset:128 nt
    buffer_load_dwordx4 v[120:123], v2, s[4:7], s17 offen offset:192 nt
    buffer_load_dwordx4 v[156:159], v3, s[8:11], s16 offen offset:0 nt
    buffer_load_dwordx4 v[160:163], v3, s[8:11], s16 offen offset:256 nt
    buffer_load_dwordx4 v[164:167], v3, s[8:11], s16 offen offset:512 nt
    buffer_load_dwordx4 v[168:171], v3, s[8:11], s16 offen offset:768 nt
    s_add_u32 s17, s16, 4096
    buffer_load_dwordx4 v[172:175], v3, s[8:11], s17 offen offset:0 nt
    buffer_load_dwordx4 v[176:179], v3, s[8:11], s17 offen offset:256 nt
    buffer_load_dwordx4 v[180:183], v3, s[8:11], s17 offen offset:512 nt
    buffer_load_dwordx4 v[184:187], v3, s[8:11], s17 offen offset:768 nt
    s_add_u32 s16, s16, 8192
    s_waitcnt vmcnt(24)
    v_mfma_f32_16x16x32_bf16 v[36:39], v[60:63], v[20:23], 0
    v_mfma_f32_16x16x32_bf16 v[36:39], v[64:67], v[24:27], v[36:39]
    v_mfma_f32_16x16x32_bf16 v[36:39], v[68:71], v[28:31], v[36:39]
    v_mfma_f32_16x16x32_bf16 v[36:39], v[72:75], v[32:35], v[36:39]
    v_mfma_f32_16x16x32_bf16 v[40:43], v[76:79], v[20:23], 0
    v_mfma_f32_16x16x32_bf16 v[40:43], v[80:83], v[24:27], v[40:43]
    v_mfma_f32_16x16x32_bf16 v[40:43], v[84:87], v[28:31], v[40:43]
    v_mfma_f32_16x16x32_bf16 v[40:43], v[88:91], v[32:35], v[40:43]
    s_nop 7
    v_max3_f32 v13, v36, v37, v38
    v_max3_f32 v13, v13, v39, v40
    v_max3_f32 v13, v13, v41, v42
    v_max_f32 v13, v13, v43
    v_mov_b32 v14, v13
    s_nop 1
    v_permlane32_swap_b32 v13, v14
    v_max_f32 v13, v13, v14
    v_mov_b32 v14, v13
    s_nop 1
    v_permlane16_swap_b32 v13, v14
    v_max_f32 v13, v13, v14
    v_max_f32 v14, v9, v13
    v_sub_f32 v13, v9, v14
    v_mul_f32 v13, s20, v13
    v_exp_f32 v11, v13
    v_mul_f32 v12, s20, v14
    v_mov_b32 v9, v14
    v_fma_f32 v44, v36, s20, -v12
    v_fma_f32 v45, v37, s20, -v12
    v_fma_f32 v46, v38, s20, -v12
    v_fma_f32 v47, v39, s20, -v12
    v_fma_f32 v48, v40, s20, -v12
    v_fma_f32 v49, v41, s20, -v12
    v_fma_f32 v50, v42, s20, -v12
    v_fma_f32 v51, v43, s20, -v12
    v_exp_f32 v44, v44
    v_exp_f32 v45, v45
    v_exp_f32 v46, v46
    v_exp_f32 v47, v47
    v_exp_f32 v48, v48
    v_exp_f32 v49, v49
    v_exp_f32 v50, v50
    v_exp_f32 v51, v51
    v_mul_f32 v16, v16, v11
    v_mul_f32 v17, v17, v11
    v_mul_f32 v18, v18, v11
    v_mul_f32 v19, v19, v11
    v_fma_f32 v10, v10, v11, v44
    v_add_f32 v10, v10, v45
    v_add_f32 v10, v10, v46
    v_add_f32 v10, v10, v47
    v_add_f32 v10, v10, v48
    v_add_f32 v10, v10, v49
    v_add_f32 v10, v10, v50
    v_add_f32 v10, v10, v51
    s_waitcnt vmcnt(16)
    v_cvt_pk_bf16_f32 v13, v44, v44
    v_and_b32 v52, v13, v4
    v_and_b32 v53, v13, v5
    v_and_b32 v54, v13, v6
    v_and_b32 v55, v13, v7
    s_nop 1
    v_mfma_f32_16x16x32_bf16 v[16:19], v[124:127], v[52:55], v[16:19]
    v_cvt_pk_bf16_f32 v13, v45, v45
    v_and_b32 v56, v13, v4
    v_and_b32 v57, v13, v5
    v_and_b32 v58, v13, v6
    v_and_b32 v59, v13, v7
    s_nop 1
    v_mfma_f32_16x16x32_bf16 v[16:19], v[128:131], v[56:59], v[16:19]
    v_cvt_pk_bf16_f32 v13, v46, v46
    v_and_b32 v52, v13, v4
    v_and_b32 v53, v13, v5
    v_and_b32 v54, v13, v6
    v_and_b32 v55, v13, v7
    s_nop 1
    v_mfma_f32_16x16x32_bf16 v[16:19], v[132:135], v[52:55], v[16:19]
    v_cvt_pk_bf16_f32 v13, v47, v47
    v_and_b32 v56, v13, v4
    v_and_b32 v57, v13, v5
    v_and_b32 v58, v13, v6
    v_and_b32 v59, v13, v7
    s_nop 1
    v_mfma_f32_16x16x32_bf16 v[16:19], v[136:139], v[56:59], v[16:19]
    v_cvt_pk_bf16_f32 v13, v48, v48
    v_and_b32 v52, v13, v4
    v_and_b32 v53, v13, v5
    v_and_b32 v54, v13, v6
    v_and_b32 v55, v13, v7
    s_nop 1
    v_mfma_f32_16x16x32_bf16 v[16:19], v[140:143], v[52:55], v[16:19]
    v_cvt_pk_bf16_f32 v13, v49, v49
    v_and_b32 v56, v13, v4
    v_and_b32 v57, v13, v5
    v_and_b32 v58, v13, v6
    v_and_b32 v59, v13, v7
    s_nop 1
    v_mfma_f32_16x16x32_bf16 v[16:19], v[144:147], v[56:59], v[16:19]
    v_cvt_pk_bf16_f32 v13, v50, v50
    v_and_b32 v52, v13, v4
    v_and_b32 v53, v13, v5
    v_and_b32 v54, v13, v6
    v_and_b32 v55, v13, v7
    s_nop 1
    v_mfma_f32_16x16x32_bf16 v[16:19], v[148:151], v[52:55], v[16:19]
    v_cvt_pk_bf16_f32 v13, v51, v51
    v_and_b32 v56, v13, v4
    v_and_b32 v57, v13, v5
    v_and_b32 v58, v13, v6
    v_and_b32 v59, v13, v7
    s_nop 1
    v_mfma_f32_16x16x32_bf16 v[16:19], v[152:155], v[56:59], v[16:19]
    s_add_u32 s17, s16, 0
    buffer_load_dwordx4 v[60:63], v2, s[4:7], s16 offen offset:0 nt
    buffer_load_dwordx4 v[64:67], v2, s[4:7], s16 offen offset:64 nt
    buffer_load_dwordx4 v[68:71], v2, s[4:7], s16 offen offset:128 nt
    buffer_load_dwordx4 v[72:75], v2, s[4:7], s16 offen offset:192 nt
    s_add_u32 s17, s16, 4096
    buffer_load_dwordx4 v[76:79], v2, s[4:7], s17 offen offset:0 nt
    buffer_load_dwordx4 v[80:83], v2, s[4:7], s17 offen offset:64 nt
    buffer_load_dwordx4 v[84:87], v2, s[4:7], s17 offen offset:128 nt
    buffer_load_dwordx4 v[88:91], v2, s[4:7], s17 offen offset:192 nt
    buffer_load_dwordx4 v[124:127], v3, s[8:11], s16 offen offset:0 nt
    buffer_load_dwordx4 v[128:131], v3, s[8:11], s16 offen offset:256 nt
    buffer_load_dwordx4 v[132:135], v3, s[8:11], s16 offen offset:512 nt
    buffer_load_dwordx4 v[136:139], v3, s[8:11], s16 offen offset:768 nt
    s_add_u32 s17, s16, 4096
    buffer_load_dwordx4 v[140:143], v3, s[8:11], s17 offen offset:0 nt
    buffer_load_dwordx4 v[144:147], v3, s[8:11], s17 offen offset:256 nt
    buffer_load_dwordx4 v[148:151], v3, s[8:11], s17 offen offset:512 nt
    buffer_load_dwordx4 v[152:155], v3, s[8:11], s17 offen offset:768 nt
    s_add_u32 s16, s16, 8192
    s_waitcnt vmcnt(24)
    v_mfma_f32_16x16x32_bf16 v[36:39], v[92:95], v[20:23], 0
    v_mfma_f32_16x16x32_bf16 v[36:39], v[96:99], v[24:27], v[36:39]
    v_mfma_f32_16x16x32_bf16 v[36:39], v[100:103], v[28:31], v[36:39]
    v_mfma_f32_16x16x32_bf16 v[36:39], v[104:107], v[32:35], v[36:39]
    v_mfma_f32_16x16x32_bf16 v[40:43], v[108:111], v[20:23], 0
    v_mfma_f32_16x16x32_bf16 v[40:43], v[112:115], v[24:27], v[40:43]
    v_mfma_f32_16x16x32_bf16 v[40:43], v[116:119], v[28:31], v[40:43]
    v_mfma_f32_16x16x32_bf16 v[40:43], v[120:123], v[32:35], v[40:43]
    s_nop 7
    v_max3_f32 v13, v36, v37, v38
    v_max3_f32 v13, v13, v39, v40
    v_max3_f32 v13, v13, v41, v42
    v_max_f32 v13, v13, v43
    v_mov_b32 v14, v13
    s_nop 1
    v_permlane32_swap_b32 v13, v14
    v_max_f32 v13, v13, v14
    v_mov_b32 v14, v13
    s_nop 1
    v_permlane16_swap_b32 v13, v14
    v_max_f32 v13, v13, v14
    v_max_f32 v14, v9, v13
    v_sub_f32 v13, v9, v14
    v_mul_f32 v13, s20, v13
    v_exp_f32 v11, v13
    v_mul_f32 v12, s20, v14
    v_mov_b32 v9, v14
    v_fma_f32 v44, v36, s20, -v12
    v_fma_f32 v45, v37, s20, -v12
    v_fma_f32 v46, v38, s20, -v12
    v_fma_f32 v47, v39, s20, -v12
    v_fma_f32 v48, v40, s20, -v12
    v_fma_f32 v49, v41, s20, -v12
    v_fma_f32 v50, v42, s20, -v12
    v_fma_f32 v51, v43, s20, -v12
    v_exp_f32 v44, v44
    v_exp_f32 v45, v45
    v_exp_f32 v46, v46
    v_exp_f32 v47, v47
    v_exp_f32 v48, v48
    v_exp_f32 v49, v49
    v_exp_f32 v50, v50
    v_exp_f32 v51, v51
    v_mul_f32 v16, v16, v11
    v_mul_f32 v17, v17, v11
    v_mul_f32 v18, v18, v11
    v_mul_f32 v19, v19, v11
    v_fma_f32 v10, v10, v11, v44
    v_add_f32 v10, v10, v45
    v_add_f32 v10, v10, v46
    v_add_f32 v10, v10, v47
    v_add_f32 v10, v10, v48
    v_add_f32 v10, v10, v49
    v_add_f32 v10, v10, v50
    v_add_f32 v10, v10, v51
    s_waitcnt vmcnt(16)
    v_cvt_pk_bf16_f32 v13, v44, v44
    v_and_b32 v52, v13, v4
    v_and_b32 v53, v13, v5
    v_and_b32 v54, v13, v6
    v_and_b32 v55, v13, v7
    s_nop 1
    v_mfma_f32_16x16x32_bf16 v[16:19], v[156:159], v[52:55], v[16:19]
    v_cvt_pk_bf16_f32 v13, v45, v45
    v_and_b32 v56, v13, v4
    v_and_b32 v57, v13, v5
    v_and_b32 v58, v13, v6
    v_and_b32 v59, v13, v7
    s_nop 1
    v_mfma_f32_16x16x32_bf16 v[16:19], v[160:163], v[56:59], v[16:19]
    v_cvt_pk_bf16_f32 v13, v46, v46
    v_and_b32 v52, v13, v4
    v_and_b32 v53, v13, v5
    v_and_b32 v54, v13, v6
    v_and_b32 v55, v13, v7
    s_nop 1
    v_mfma_f32_16x16x32_bf16 v[16:19], v[164:167], v[52:55], v[16:19]
    v_cvt_pk_bf16_f32 v13, v47, v47
    v_and_b32 v56, v13, v4
    v_and_b32 v57, v13, v5
    v_and_b32 v58, v13, v6
    v_and_b32 v59, v13, v7
    s_nop 1
    v_mfma_f32_16x16x32_bf16 v[16:19], v[168:171], v[56:59], v[16:19]
    v_cvt_pk_bf16_f32 v13, v48, v48
    v_and_b32 v52, v13, v4
    v_and_b32 v53, v13, v5
    v_and_b32 v54, v13, v6
    v_and_b32 v55, v13, v7
    s_nop 1
    v_mfma_f32_16x16x32_bf16 v[16:19], v[172:175], v[52:55], v[16:19]
    v_cvt_pk_bf16_f32 v13, v49, v49
    v_and_b32 v56, v13, v4
    v_and_b32 v57, v13, v5
    v_and_b32 v58, v13, v6
    v_and_b32 v59, v13, v7
    s_nop 1
    v_mfma_f32_16x16x32_bf16 v[16:19], v[176:179], v[56:59], v[16:19]
    v_cvt_pk_bf16_f32 v13, v50, v50
    v_and_b32 v52, v13, v4
    v_and_b32 v53, v13, v5
    v_and_b32 v54, v13, v6
    v_and_b32 v55, v13, v7
    s_nop 1
    v_mfma_f32_16x16x32_bf16 v[16:19], v[180:183], v[52:55], v[16:19]
    v_cvt_pk_bf16_f32 v13, v51, v51
    v_and_b32 v56, v13, v4
    v_and_b32 v57, v13, v5
    v_and_b32 v58, v13, v6
    v_and_b32 v59, v13, v7
    s_nop 1
    v_mfma_f32_16x16x32_bf16 v[16:19], v[184:187], v[56:59], v[16:19]
    s_sub_u32 s18, s18, 1
    s_cmp_lg_u32 s18, 0
    s_cbranch_scc1 gmix_b_kernel_loop
    s_add_u32 s17, s16, 0
    buffer_load_dwordx4 v[92:95], v2, s[4:7], s16 offen offset:0 nt
    buffer_load_dwordx4 v[96:99], v2, s[4:7], s16 offen offset:64 nt
    buffer_load_dwordx4 v[100:103], v2, s[4:7], s16 offen offset:128 nt
    buffer_load_dwordx4 v[104:107], v2, s[4:7], s16 offen offset:192 nt
    s_add_u32 s17, s16, 4096
    buffer_load_dwordx4 v[108:111], v2, s[4:7], s17 offen offset:0 nt
    buffer_load_dwordx4 v[112:115], v2, s[4:7], s17 offen offset:64 nt
    buffer_load_dwordx4 v[116:119], v2, s[4:7], s17 offen offset:128 nt
    buffer_load_dwordx4 v[120:123], v2, s[4:7], s17 offen offset:192 nt
    buffer_load_dwordx4 v[156:159], v3, s[8:11], s16 offen offset:0 nt
    buffer_load_dwordx4 v[160:163], v3, s[8:11], s16 offen offset:256 nt
    buffer_load_dwordx4 v[164:167], v3, s[8:11], s16 offen offset:512 nt
    buffer_load_dwordx4 v[168:171], v3, s[8:11], s16 offen offset:768 nt
    s_add_u32 s17, s16, 4096
    buffer_load_dwordx4 v[172:175], v3, s[8:11], s17 offen offset:0 nt
    buffer_load_dwordx4 v[176:179], v3, s[8:11], s17 offen offset:256 nt
    buffer_load_dwordx4 v[180:183], v3, s[8:11], s17 offen offset:512 nt
    buffer_load_dwordx4 v[184:187], v3, s[8:11], s17 offen offset:768 nt
    s_add_u32 s16, s16, 8192
    s_waitcnt vmcnt(24)
    v_mfma_f32_16x16x32_bf16 v[36:39], v[60:63], v[20:23], 0
    v_mfma_f32_16x16x32_bf16 v[36:39], v[64:67], v[24:27], v[36:39]
    v_mfma_f32_16x16x32_bf16 v[36:39], v[68:71], v[28:31], v[36:39]
    v_mfma_f32_16x16x32_bf16 v[36:39], v[72:75], v[32:35], v[36:39]
    v_mfma_f32_16x16x32_bf16 v[40:43], v[76:79], v[20:23], 0
    v_mfma_f32_16x16x32_bf16 v[40:43], v[80:83], v[24:27], v[40:43]
    v_mfma_f32_16x16x32_bf16 v[40:43], v[84:87], v[28:31], v[40:43]
    v_mfma_f32_16x16x32_bf16 v[40:43], v[88:91], v[32:35], v[40:43]
    s_nop 7
    v_max3_f32 v13, v36, v37, v38
    v_max3_f32 v13, v13, v39, v40
    v_max3_f32 v13, v13, v41, v42
    v_max_f32 v13, v13, v43
    v_mov_b32 v14, v13
    s_nop 1
    v_permlane32_swap_b32 v13, v14
    v_max_f32 v13, v13, v14
    v_mov_b32 v14, v13
    s_nop 1
    v_permlane16_swap_b32 v13, v14
    v_max_f32 v13, v13, v14
    v_max_f32 v14, v9, v13
    v_sub_f32 v13, v9, v14
    v_mul_f32 v13, s20, v13
    v_exp_f32 v11, v13
    v_mul_f32 v12, s20, v14
    v_mov_b32 v9, v14
    v_fma_f32 v44, v36, s20, -v12
    v_fma_f32 v45, v37, s20, -v12
    v_fma_f32 v46, v38, s20, -v12
    v_fma_f32 v47, v39, s20, -v12
    v_fma_f32 v48, v40, s20, -v12
    v_fma_f32 v49, v41, s20, -v12
    v_fma_f32 v50, v42, s20, -v12
    v_fma_f32 v51, v43, s20, -v12
    v_exp_f32 v44, v44
    v_exp_f32 v45, v45
    v_exp_f32 v46, v46
    v_exp_f32 v47, v47
    v_exp_f32 v48, v48
    v_exp_f32 v49, v49
    v_exp_f32 v50, v50
    v_exp_f32 v51, v51
    v_mul_f32 v16, v16, v11
    v_mul_f32 v17, v17, v11
    v_mul_f32 v18, v18, v11
    v_mul_f32 v19, v19, v11
    v_fma_f32 v10, v10, v11, v44
    v_add_f32 v10, v10, v45
    v_add_f32 v10, v10, v46
    v_add_f32 v10, v10, v47
    v_add_f32 v10, v10, v48
    v_add_f32 v10, v10, v49
    v_add_f32 v10, v10, v50
    v_add_f32 v10, v10, v51
    s_waitcnt vmcnt(16)
    v_cvt_pk_bf16_f32 v13, v44, v44
    v_and_b32 v52, v13, v4
    v_and_b32 v53, v13, v5
    v_and_b32 v54, v13, v6
    v_and_b32 v55, v13, v7
    s_nop 1
    v_mfma_f32_16x16x32_bf16 v[16:19], v[124:127], v[52:55], v[16:19]
    v_cvt_pk_bf16_f32 v13, v45, v45
    v_and_b32 v56, v13, v4
    v_and_b32 v57, v13, v5
    v_and_b32 v58, v13, v6
    v_and_b32 v59, v13, v7
    s_nop 1
    v_mfma_f32_16x16x32_bf16 v[16:19], v[128:131], v[56:59], v[16:19]
    v_cvt_pk_bf16_f32 v13, v46, v46
    v_and_b32 v52, v13, v4
    v_and_b32 v53, v13, v5
    v_and_b32 v54, v13, v6
    v_and_b32 v55, v13, v7
    s_nop 1
    v_mfma_f32_16x16x32_bf16 v[16:19], v[132:135], v[52:55], v[16:19]
    v_cvt_pk_bf16_f32 v13, v47, v47
    v_and_b32 v56, v13, v4
    v_and_b32 v57, v13, v5
    v_and_b32 v58, v13, v6
    v_and_b32 v59, v13, v7
    s_nop 1
    v_mfma_f32_16x16x32_bf16 v[16:19], v[136:139], v[56:59], v[16:19]
    v_cvt_pk_bf16_f32 v13, v48, v48
    v_and_b32 v52, v13, v4
    v_and_b32 v53, v13, v5
    v_and_b32 v54, v13, v6
    v_and_b32 v55, v13, v7
    s_nop 1
    v_mfma_f32_16x16x32_bf16 v[16:19], v[140:143], v[52:55], v[16:19]
    v_cvt_pk_bf16_f32 v13, v49, v49
    v_and_b32 v56, v13, v4
    v_and_b32 v57, v13, v5
    v_and_b32 v58, v13, v6
    v_and_b32 v59, v13, v7
    s_nop 1
    v_mfma_f32_16x16x32_bf16 v[16:19], v[144:147], v[56:59], v[16:19]
    v_cvt_pk_bf16_f32 v13, v50, v50
    v_and_b32 v52, v13, v4
    v_and_b32 v53, v13, v5
    v_and_b32 v54, v13, v6
    v_and_b32 v55, v13, v7
    s_nop 1
    v_mfma_f32_16x16x32_bf16 v[16:19], v[148:151], v[52:55], v[16:19]
    v_cvt_pk_bf16_f32 v13, v51, v51
    v_and_b32 v56, v13, v4
    v_and_b32 v57, v13, v5
    v_and_b32 v58, v13, v6
    v_and_b32 v59, v13, v7
    s_nop 1
    v_mfma_f32_16x16x32_bf16 v[16:19], v[152:155], v[56:59], v[16:19]
    s_waitcnt vmcnt(8)
    v_mfma_f32_16x16x32_bf16 v[36:39], v[92:95], v[20:23], 0
    v_mfma_f32_16x16x32_bf16 v[36:39], v[96:99], v[24:27], v[36:39]
    v_mfma_f32_16x16x32_bf16 v[36:39], v[100:103], v[28:31], v[36:39]
    v_mfma_f32_16x16x32_bf16 v[36:39], v[104:107], v[32:35], v[36:39]
    v_mfma_f32_16x16x32_bf16 v[40:43], v[108:111], v[20:23], 0
    v_mfma_f32_16x16x32_bf16 v[40:43], v[112:115], v[24:27], v[40:43]
    v_mfma_f32_16x16x32_bf16 v[40:43], v[116:119], v[28:31], v[40:43]
    v_mfma_f32_16x16x32_bf16 v[40:43], v[120:123], v[32:35], v[40:43]
    s_nop 7
    v_max3_f32 v13, v36, v37, v38
    v_max3_f32 v13, v13, v39, v40
    v_max3_f32 v13, v13, v41, v42
    v_max_f32 v13, v13, v43
    v_mov_b32 v14, v13
    s_nop 1
    v_permlane32_swap_b32 v13, v14
    v_max_f32 v13, v13, v14
    v_mov_b32 v14, v13
    s_nop 1
    v_permlane16_swap_b32 v13, v14
    v_max_f32 v13, v13, v14
    v_max_f32 v14, v9, v13
    v_sub_f32 v13, v9, v14
    v_mul_f32 v13, s20, v13
    v_exp_f32 v11, v13
    v_mul_f32 v12, s20, v14
    v_mov_b32 v9, v14
    v_fma_f32 v44, v36, s20, -v12
    v_fma_f32 v45, v37, s20, -v12
    v_fma_f32 v46, v38, s20, -v12
    v_fma_f32 v47, v39, s20, -v12
    v_fma_f32 v48, v40, s20, -v12
    v_fma_f32 v49, v41, s20, -v12
    v_fma_f32 v50, v42, s20, -v12
    v_fma_f32 v51, v43, s20, -v12
    v_exp_f32 v44, v44
    v_exp_f32 v45, v45
    v_exp_f32 v46, v46
    v_exp_f32 v47, v47
    v_exp_f32 v48, v48
    v_exp_f32 v49, v49
    v_exp_f32 v50, v50
    v_exp_f32 v51, v51
    v_mul_f32 v16, v16, v11
    v_mul_f32 v17, v17, v11
    v_mul_f32 v18, v18, v11
    v_mul_f32 v19, v19, v11
    v_fma_f32 v10, v10, v11, v44
    v_add_f32 v10, v10, v45
    v_add_f32 v10, v10, v46
    v_add_f32 v10, v10, v47
    v_add_f32 v10, v10, v48
    v_add_f32 v10, v10, v49
    v_add_f32 v10, v10, v50
    v_add_f32 v10, v10, v51
    s_waitcnt vmcnt(0)
    v_cvt_pk_bf16_f32 v13, v44, v44
    v_and_b32 v52, v13, v4
    v_and_b32 v53, v13, v5
    v_and_b32 v54, v13, v6
    v_and_b32 v55, v13, v7
    s_nop 1
    v_mfma_f32_16x16x32_bf16 v[16:19], v[156:159], v[52:55], v[16:19]
    v_cvt_pk_bf16_f32 v13, v45, v45
    v_and_b32 v56, v13, v4
    v_and_b32 v57, v13, v5
    v_and_b32 v58, v13, v6
    v_and_b32 v59, v13, v7
    s_nop 1
    v_mfma_f32_16x16x32_bf16 v[16:19], v[160:163], v[56:59], v[16:19]
    v_cvt_pk_bf16_f32 v13, v46, v46
    v_and_b32 v52, v13, v4
    v_and_b32 v53, v13, v5
    v_and_b32 v54, v13, v6
    v_and_b32 v55, v13, v7
    s_nop 1
    v_mfma_f32_16x16x32_bf16 v[16:19], v[164:167], v[52:55], v[16:19]
    v_cvt_pk_bf16_f32 v13, v47, v47
    v_and_b32 v56, v13, v4
    v_and_b32 v57, v13, v5
    v_and_b32 v58, v13, v6
    v_and_b32 v59, v13, v7
    s_nop 1
    v_mfma_f32_16x16x32_bf16 v[16:19], v[168:171], v[56:59], v[16:19]
    v_cvt_pk_bf16_f32 v13, v48, v48
    v_and_b32 v52, v13, v4
    v_and_b32 v53, v13, v5
    v_and_b32 v54, v13, v6
    v_and_b32 v55, v13, v7
    s_nop 1
    v_mfma_f32_16x16x32_bf16 v[16:19], v[172:175], v[52:55], v[16:19]
    v_cvt_pk_bf16_f32 v13, v49, v49
    v_and_b32 v56, v13, v4
    v_and_b32 v57, v13, v5
    v_and_b32 v58, v13, v6
    v_and_b32 v59, v13, v7
    s_nop 1
    v_mfma_f32_16x16x32_bf16 v[16:19], v[176:179], v[56:59], v[16:19]
    v_cvt_pk_bf16_f32 v13, v50, v50
    v_and_b32 v52, v13, v4
    v_and_b32 v53, v13, v5
    v_and_b32 v54, v13, v6
    v_and_b32 v55, v13, v7
    s_nop 1
    v_mfma_f32_16x16x32_bf16 v[16:19], v[180:183], v[52:55], v[16:19]
    v_cvt_pk_bf16_f32 v13, v51, v51
    v_and_b32 v56, v13, v4
    v_and_b32 v57, v13, v5
    v_and_b32 v58, v13, v6
    v_and_b32 v59, v13, v7
    s_nop 1
    v_mfma_f32_16x16x32_bf16 v[16:19], v[184:187], v[56:59], v[16:19]
    s_nop 7
    v_mov_b32 v14, v10
    s_nop 1
    v_permlane32_swap_b32 v10, v14
    v_add_f32 v10, v10, v14
    v_mov_b32 v14, v10
    s_nop 1
    v_permlane16_swap_b32 v10, v14
    v_add_f32 v10, v10, v14
    s_lshl_b32 s21, s19, 10
    v_lshl_add_u32 v13, v1, 4, s21
    ds_write_b128 v13, v[16:19]
    v_and_b32 v14, 8, v1
    s_lshl_b32 s21, s19, 4
    s_add_u32 s21, s21, 8192
    v_add_u32 v14, s21, v14
    v_mov_b32 v36, v9
    v_mov_b32 v37, v10
    ds_write_b64 v14, v[36:37]
    s_waitcnt lgkmcnt(0)
    s_barrier
    s_cmp_lg_u32 s19, 0
    s_cbranch_scc1 gmix_b_kernel_end
    v_and_b32 v14, 8, v1
    ds_read_b64 v[60:61], v14 offset:8192
    ds_read_b64 v[62:63], v14 offset:8208
    ds_read_b64 v[64:65], v14 offset:8224
    ds_read_b64 v[66:67], v14 offset:8240
    ds_read_b64 v[68:69], v14 offset:8256
    ds_read_b64 v[70:71], v14 offset:8272
    ds_read_b64 v[72:73], v14 offset:8288
    ds_read_b64 v[74:75], v14 offset:8304
    v_lshlrev_b32 v13, 4, v1
    ds_read_b128 v[124:127], v13 offset:0
    ds_read_b128 v[128:131], v13 offset:1024
    ds_read_b128 v[132:135], v13 offset:2048
    ds_read_b128 v[136:139], v13 offset:3072
    ds_read_b128 v[140:143], v13 offset:4096
    ds_read_b128 v[144:147], v13 offset:5120
    ds_read_b128 v[148:151], v13 offset:6144
    ds_read_b128 v[152:155], v13 offset:7168
    s_waitcnt lgkmcnt(0)
    v_mov_b32 v9, v60
    v_max_f32 v9, v9, v62
    v_max_f32 v9, v9, v64
    v_max_f32 v9, v9, v66
    v_max_f32 v9, v9, v68
    v_max_f32 v9, v9, v70
    v_max_f32 v9, v9, v72
    v_max_f32 v9, v9, v74
    v_mov_b32 v10, 0
    v_mov_b32 v16, 0
    v_mov_b32 v17, 0
    v_mov_b32 v18, 0
    v_mov_b32 v19, 0
    v_sub_f32 v13, v60, v9
    v_mul_f32 v13, s20, v13
    v_exp_f32 v13, v13
    s_nop 0
    v_fma_f32 v10, v13, v61, v10
    v_fma_f32 v16, v13, v124, v16
    v_fma_f32 v17, v13, v125, v17
    v_fma_f32 v18, v13, v126, v18
    v_fma_f32 v19, v13, v127, v19
    v_sub_f32 v13, v62, v9
    v_mul_f32 v13, s20, v13
    v_exp_f32 v13, v13
    s_nop 0
    v_fma_f32 v10, v13, v63, v10
    v_fma_f32 v16, v13, v128, v16
    v_fma_f32 v17, v13, v129, v17
    v_fma_f32 v18, v13, v130, v18
    v_fma_f32 v19, v13, v131, v19
    v_sub_f32 v13, v64, v9
    v_mul_f32 v13, s20, v13
    v_exp_f32 v13, v13
    s_nop 0
    v_fma_f32 v10, v13, v65, v10
    v_fma_f32 v16, v13, v132, v16
    v_fma_f32 v17, v13, v133, v17
    v_fma_f32 v18, v13, v134, v18
    v_fma_f32 v19, v13, v135, v19
    v_sub_f32 v13, v66, v9
    v_mul_f32 v13, s20, v13
    v_exp_f32 v13, v13
    s_nop 0
    v_fma_f32 v10, v13, v67, v10
    v_fma_f32 v16, v13, v136, v16
    v_fma_f32 v17, v13, v137, v17
    v_fma_f32 v18, v13, v138, v18
    v_fma_f32 v19, v13, v139, v19
    v_sub_f32 v13, v68, v9
    v_mul_f32 v13, s20, v13
    v_exp_f32 v13, v13
    s_nop 0
    v_fma_f32 v10, v13, v69, v10
    v_fma_f32 v16, v13, v140, v16
    v_fma_f32 v17, v13, v141, v17
    v_fma_f32 v18, v13, v142, v18
    v_fma_f32 v19, v13, v143, v19
    v_sub_f32 v13, v70, v9
    v_mul_f32 v13, s20, v13
    v_exp_f32 v13, v13
    s_nop 0
    v_fma_f32 v10, v13, v71, v10
    v_fma_f32 v16, v13, v144, v16
    v_fma_f32 v17, v13, v145, v17
    v_fma_f32 v18, v13, v146, v18
    v_fma_f32 v19, v13, v147, v19
    v_sub_f32 v13, v72, v9
    v_mul_f32 v13, s20, v13
    v_exp_f32 v13, v13
    s_nop 0
    v_fma_f32 v10, v13, v73, v10
    v_fma_f32 v16, v13, v148, v16
    v_fma_f32 v17, v13, v149, v17
    v_fma_f32 v18, v13, v150, v18
    v_fma_f32 v19, v13, v151, v19
    v_sub_f32 v13, v74, v9
    v_mul_f32 v13, s20, v13
    v_exp_f32 v13, v13
    s_nop 0
    v_fma_f32 v10, v13, v75, v10
    v_fma_f32 v16, v13, v152, v16
    v_fma_f32 v17, v13, v153, v17
    v_fma_f32 v18, v13, v154, v18
    v_fma_f32 v19, v13, v155, v19
    s_lshl_b32 s21, s2, 10
    v_lshl_add_u32 v13, v1, 4, s21
    v_add_u32 v13, 0x80000, v13
    buffer_store_dwordx4 v[16:19], v13, s[12:15], 0 offen
    v_and_b32 v14, 8, v1
    s_lshl_b32 s21, s2, 4
    s_add_u32 s21, s21, 0x40000
    v_add_u32 v14, s21, v14
    v_mov_b32 v36, v9
    v_mov_b32 v37, v10
    buffer_store_dwordx2 v[36:37], v14, s[12:15], 0 offen
    s_waitcnt vmcnt(0)
gmix_b_kernel_end:
    s_endpgm
.globl gmix_c_kernel
.p2align 8
.type gmix_c_kernel,@function
gmix_c_kernel:
    s_cmp_ge_u32 s2, 256
    s_cbranch_scc1 gmix_c_kernel_end
    s_load_dwordx2 s[30:31], s[0:1], 96
    s_load_dwordx2 s[32:33], s[0:1], 32
    s_load_dwordx2 s[34:35], s[0:1], 64
    s_load_dwordx4 s[36:39], s[0:1], 80
    v_and_b32 v1, 63, v0
    v_lshrrev_b32 v2, 6, v0
    s_nop 0
    v_readfirstlane_b32 s24, v2
    s_waitcnt lgkmcnt(0)
    s_mov_b32 s4, s30
    s_and_b32 s5, s31, 0xffff
    s_mov_b32 s6, 1048576
    s_mov_b32 s7, 0x00020000
    s_mov_b32 s8, s32
    s_and_b32 s9, s33, 0xffff
    s_mov_b32 s10, 4718592
    s_mov_b32 s11, 0x00020000
    s_mov_b32 s12, s34
    s_and_b32 s13, s35, 0xffff
    s_mov_b32 s14, 5308416
    s_mov_b32 s15, 0x00020000
    s_mov_b32 s16, s36
    s_and_b32 s17, s37, 0xffff
    s_mov_b32 s18, 2304
    s_mov_b32 s19, 0x00020000
    s_mov_b32 s20, s38
    s_and_b32 s21, s39, 0xffff
    s_mov_b32 s22, 256
    s_mov_b32 s23, 0x00020000
    s_mov_b32 s28, 0x3e0293ee
    v_and_b32 v2, 15, v1
    v_lshrrev_b32 v3, 4, v1
    v_mul_u32_u24 v5, 1152, v3
    v_lshl_add_u32 v5, v2, 4, v5
    s_mul_i32 s25, s2, 18432
    s_lshl_b32 s26, s24, 8
    s_add_u32 s25, s25, s26
    buffer_load_dwordx4 v[82:85], v5, s[8:11], s25 offen
    s_add_u32 s25, s25, 4608
    buffer_load_dwordx4 v[86:89], v5, s[8:11], s25 offen
    s_add_u32 s25, s25, 4608
    buffer_load_dwordx4 v[90:93], v5, s[8:11], s25 offen
    s_add_u32 s25, s25, 4608
    buffer_load_dwordx4 v[94:97], v5, s[8:11], s25 offen
    s_add_u32 s25, s25, 4608
    s_mul_i32 s25, s2, 20736
    s_add_u32 s25, s25, s26
    buffer_load_dwordx4 v[98:101], v5, s[12:15], s25 offen
    s_add_u32 s25, s25, 4608
    buffer_load_dwordx4 v[102:105], v5, s[12:15], s25 offen
    s_add_u32 s25, s25, 4608
    buffer_load_dwordx4 v[106:109], v5, s[12:15], s25 offen
    s_add_u32 s25, s25, 4608
    buffer_load_dwordx4 v[110:113], v5, s[12:15], s25 offen
    s_add_u32 s25, s25, 4608
    buffer_load_dwordx4 v[114:117], v5, s[12:15], s25 offen
    s_add_u32 s25, s25, 4608
    v_lshrrev_b32 v4, 3, v2
    v_mul_u32_u24 v128, 4608, v4
    v_add_u32 v128, v128, v3
    s_mul_i32 s25, s2, 18
    v_add_u32 v128, s25, v128
    v_lshlrev_b32 v128, 1, v128
    v_lshlrev_b32 v128, 1, v128
    s_mov_b32 s27, 0xc0000
    buffer_load_dword v136, v128, s[4:7], s27 offen offset:0
    buffer_load_dword v137, v128, s[4:7], s27 offen offset:16
    buffer_load_dword v138, v128, s[4:7], s27 offen offset:32
    buffer_load_dword v139, v128, s[4:7], s27 offen offset:48
    buffer_load_dword v140, v128, s[4:7], s27 offen offset:64
    s_mov_b32 s27, 0xc9000
    buffer_load_dword v141, v128, s[4:7], s27 offen offset:0
    buffer_load_dword v142, v128, s[4:7], s27 offen offset:16
    buffer_load_dword v143, v128, s[4:7], s27 offen offset:32
    buffer_load_dword v144, v128, s[4:7], s27 offen offset:48
    buffer_load_dword v145, v128, s[4:7], s27 offen offset:64
    s_mov_b32 s27, 0xd2000
    buffer_load_dword v146, v128, s[4:7], s27 offen offset:0
    buffer_load_dword v147, v128, s[4:7], s27 offen offset:16
    buffer_load_dword v148, v128, s[4:7], s27 offen offset:32
    buffer_load_dword v149, v128, s[4:7], s27 offen offset:48
    buffer_load_dword v150, v128, s[4:7], s27 offen offset:64
    s_mov_b32 s27, 0xdb000
    buffer_load_dword v151, v128, s[4:7], s27 offen offset:0
    buffer_load_dword v152, v128, s[4:7], s27 offen offset:16
    buffer_load_dword v153, v128, s[4:7], s27 offen offset:32
    buffer_load_dword v154, v128, s[4:7], s27 offen offset:48
    buffer_load_dword v155, v128, s[4:7], s27 offen offset:64
    s_mov_b32 s27, 0xe4000
    buffer_load_dword v156, v128, s[4:7], s27 offen offset:0
    buffer_load_dword v157, v128, s[4:7], s27 offen offset:16
    buffer_load_dword v158, v128, s[4:7], s27 offen offset:32
    buffer_load_dword v159, v128, s[4:7], s27 offen offset:48
    buffer_load_dword v160, v128, s[4:7], s27 offen offset:64
    s_mov_b32 s27, 0xed000
    buffer_load_dword v161, v128, s[4:7], s27 offen offset:0
    buffer_load_dword v162, v128, s[4:7], s27 offen offset:16
    buffer_load_dword v163, v128, s[4:7], s27 offen offset:32
    buffer_load_dword v164, v128, s[4:7], s27 offen offset:48
    buffer_load_dword v165, v128, s[4:7], s27 offen offset:64
    v_lshlrev_b32 v128, 2, v4
    s_mov_b32 s27, 0x10000
    buffer_load_dword v126, v128, s[4:7], s27 offen
    s_lshr_b32 s25, s2, 3
    s_and_b32 s26, s25, 1
    s_lshr_b32 s25, s25, 1
    s_and_b32 s27, s25, 1
    s_lshl_b32 s27, s27, 3
    s_lshr_b32 s25, s25, 1
    s_add_u32 s25, s25, s27
    v_lshlrev_b32 v128, 4, v4
    v_add_u32 v128, s25, v128
    v_lshlrev_b32 v129, 4, v128
    s_lshl_b32 s27, s26, 3
    s_add_u32 s27, s27, 0x40000
    buffer_load_dwordx2 v[28:29], v129, s[4:7], s27 offen offset:0
    buffer_load_dwordx2 v[30:31], v129, s[4:7], s27 offen offset:512
    buffer_load_dwordx2 v[32:33], v129, s[4:7], s27 offen offset:1024
    buffer_load_dwordx2 v[34:35], v129, s[4:7], s27 offen offset:1536
    buffer_load_dwordx2 v[36:37], v129, s[4:7], s27 offen offset:2048
    buffer_load_dwordx2 v[38:39], v129, s[4:7], s27 offen offset:2560
    buffer_load_dwordx2 v[40:41], v129, s[4:7], s27 offen offset:3072
    buffer_load_dwordx2 v[42:43], v129, s[4:7], s27 offen offset:3584
    v_lshlrev_b32 v129, 10, v128
    s_and_b32 s27, s2, 7
    v_add_u32 v2, 0, v3
    v_and_b32 v4, 7, v2
    v_lshlrev_b32 v4, 4, v4
    v_lshrrev_b32 v2, 3, v2
    s_lshl_b32 s25, s27, 1
    v_add_u32 v2, s25, v2
    v_and_b32 v130, 3, v2
    v_lshl_add_u32 v4, v130, 2, v4
    v_lshrrev_b32 v2, 2, v2
    v_lshl_add_u32 v4, v2, 8, v4
    s_lshl_b32 s25, s26, 7
    v_add_u32 v4, s25, v4
    v_add_u32 v4, v4, v129
    s_mov_b32 s25, 0x80000
    buffer_load_dword v44, v4, s[4:7], s25 offen
    s_mov_b32 s25, 0x88000
    buffer_load_dword v45, v4, s[4:7], s25 offen
    s_mov_b32 s25, 0x90000
    buffer_load_dword v46, v4, s[4:7], s25 offen
    s_mov_b32 s25, 0x98000
    buffer_load_dword v47, v4, s[4:7], s25 offen
    s_mov_b32 s25, 0xa0000
    buffer_load_dword v48, v4, s[4:7], s25 offen
    s_mov_b32 s25, 0xa8000
    buffer_load_dword v49, v4, s[4:7], s25 offen
    s_mov_b32 s25, 0xb0000
    buffer_load_dword v50, v4, s[4:7], s25 offen
    s_mov_b32 s25, 0xb8000
    buffer_load_dword v51, v4, s[4:7], s25 offen
    v_add_u32 v2, 4, v3
    v_and_b32 v4, 7, v2
    v_lshlrev_b32 v4, 4, v4
    v_lshrrev_b32 v2, 3, v2
    s_lshl_b32 s25, s27, 1
    v_add_u32 v2, s25, v2
    v_and_b32 v130, 3, v2
    v_lshl_add_u32 v4, v130, 2, v4
    v_lshrrev_b32 v2, 2, v2
    v_lshl_add_u32 v4, v2, 8, v4
    s_lshl_b32 s25, s26, 7
    v_add_u32 v4, s25, v4
    v_add_u32 v4, v4, v129
    s_mov_b32 s25, 0x80000
    buffer_load_dword v52, v4, s[4:7], s25 offen
    s_mov_b32 s25, 0x88000
    buffer_load_dword v53, v4, s[4:7], s25 offen
    s_mov_b32 s25, 0x90000
    buffer_load_dword v54, v4, s[4:7], s25 offen
    s_mov_b32 s25, 0x98000
    buffer_load_dword v55, v4, s[4:7], s25 offen
    s_mov_b32 s25, 0xa0000
    buffer_load_dword v56, v4, s[4:7], s25 offen
    s_mov_b32 s25, 0xa8000
    buffer_load_dword v57, v4, s[4:7], s25 offen
    s_mov_b32 s25, 0xb0000
    buffer_load_dword v58, v4, s[4:7], s25 offen
    s_mov_b32 s25, 0xb8000
    buffer_load_dword v59, v4, s[4:7], s25 offen
    v_add_u32 v2, 8, v3
    v_and_b32 v4, 7, v2
    v_lshlrev_b32 v4, 4, v4
    v_lshrrev_b32 v2, 3, v2
    s_lshl_b32 s25, s27, 1
    v_add_u32 v2, s25, v2
    v_and_b32 v130, 3, v2
    v_lshl_add_u32 v4, v130, 2, v4
    v_lshrrev_b32 v2, 2, v2
    v_lshl_add_u32 v4, v2, 8, v4
    s_lshl_b32 s25, s26, 7
    v_add_u32 v4, s25, v4
    v_add_u32 v4, v4, v129
    s_mov_b32 s25, 0x80000
    buffer_load_dword v60, v4, s[4:7], s25 offen
    s_mov_b32 s25, 0x88000
    buffer_load_dword v61, v4, s[4:7], s25 offen
    s_mov_b32 s25, 0x90000
    buffer_load_dword v62, v4, s[4:7], s25 offen
    s_mov_b32 s25, 0x98000
    buffer_load_dword v63, v4, s[4:7], s25 offen
    s_mov_b32 s25, 0xa0000
    buffer_load_dword v64, v4, s[4:7], s25 offen
    s_mov_b32 s25, 0xa8000
    buffer_load_dword v65, v4, s[4:7], s25 offen
    s_mov_b32 s25, 0xb0000
    buffer_load_dword v66, v4, s[4:7], s25 offen
    s_mov_b32 s25, 0xb8000
    buffer_load_dword v67, v4, s[4:7], s25 offen
    v_add_u32 v2, 12, v3
    v_and_b32 v4, 7, v2
    v_lshlrev_b32 v4, 4, v4
    v_lshrrev_b32 v2, 3, v2
    s_lshl_b32 s25, s27, 1
    v_add_u32 v2, s25, v2
    v_and_b32 v130, 3, v2
    v_lshl_add_u32 v4, v130, 2, v4
    v_lshrrev_b32 v2, 2, v2
    v_lshl_add_u32 v4, v2, 8, v4
    s_lshl_b32 s25, s26, 7
    v_add_u32 v4, s25, v4
    v_add_u32 v4, v4, v129
    s_mov_b32 s25, 0x80000
    buffer_load_dword v68, v4, s[4:7], s25 offen
    s_mov_b32 s25, 0x88000
    buffer_load_dword v69, v4, s[4:7], s25 offen
    s_mov_b32 s25, 0x90000
    buffer_load_dword v70, v4, s[4:7], s25 offen
    s_mov_b32 s25, 0x98000
    buffer_load_dword v71, v4, s[4:7], s25 offen
    s_mov_b32 s25, 0xa0000
    buffer_load_dword v72, v4, s[4:7], s25 offen
    s_mov_b32 s25, 0xa8000
    buffer_load_dword v73, v4, s[4:7], s25 offen
    s_mov_b32 s25, 0xb0000
    buffer_load_dword v74, v4, s[4:7], s25 offen
    s_mov_b32 s25, 0xb8000
    buffer_load_dword v75, v4, s[4:7], s25 offen
    v_and_b32 v2, 7, v1
    v_lshrrev_b32 v9, 1, v2
    v_and_b32 v8, 1, v2
    v_mov_b32 v7, 0xffff
    v_mov_b32 v6, 0xffff0000
    v_cmp_eq_u32 vcc, 1, v8
    s_nop 1
    v_cndmask_b32 v8, v7, v6, vcc
    v_mov_b32 v6, v9
    v_mov_b32 v7, v8
    v_cmp_eq_u32 vcc, 3, v6
    s_nop 1
    v_cndmask_b32 v9, 0, v7, vcc
    v_cmp_eq_u32 vcc, 2, v6
    s_nop 1
    v_cndmask_b32 v8, 0, v7, vcc
    v_cmp_eq_u32 vcc, 1, v6
    v_mov_b32 v10, v7
    s_nop 0
    v_cndmask_b32 v7, 0, v10, vcc
    v_cmp_eq_u32 vcc, 0, v6
    s_nop 1
    v_cndmask_b32 v6, 0, v10, vcc
    s_waitcnt vmcnt(0)
    v_mov_b32 v2, v28
    v_max_f32 v2, v2, v30
    v_max_f32 v2, v2, v32
    v_max_f32 v2, v2, v34
    v_max_f32 v2, v2, v36
    v_max_f32 v2, v2, v38
    v_max_f32 v2, v2, v40
    v_max_f32 v2, v2, v42
    v_mov_b32 v3, 0
    v_sub_f32 v118, v28, v2
    v_mul_f32 v118, s28, v118
    v_exp_f32 v118, v118
    s_nop 0
    v_fma_f32 v3, v118, v29, v3
    v_sub_f32 v119, v30, v2
    v_mul_f32 v119, s28, v119
    v_exp_f32 v119, v119
    s_nop 0
    v_fma_f32 v3, v119, v31, v3
    v_sub_f32 v120, v32, v2
    v_mul_f32 v120, s28, v120
    v_exp_f32 v120, v120
    s_nop 0
    v_fma_f32 v3, v120, v33, v3
    v_sub_f32 v121, v34, v2
    v_mul_f32 v121, s28, v121
    v_exp_f32 v121, v121
    s_nop 0
    v_fma_f32 v3, v121, v35, v3
    v_sub_f32 v122, v36, v2
    v_mul_f32 v122, s28, v122
    v_exp_f32 v122, v122
    s_nop 0
    v_fma_f32 v3, v122, v37, v3
    v_sub_f32 v123, v38, v2
    v_mul_f32 v123, s28, v123
    v_exp_f32 v123, v123
    s_nop 0
    v_fma_f32 v3, v123, v39, v3
    v_sub_f32 v124, v40, v2
    v_mul_f32 v124, s28, v124
    v_exp_f32 v124, v124
    s_nop 0
    v_fma_f32 v3, v124, v41, v3
    v_sub_f32 v125, v42, v2
    v_mul_f32 v125, s28, v125
    v_exp_f32 v125, v125
    s_nop 0
    v_fma_f32 v3, v125, v43, v3
    v_rcp_f32 v3, v3
    v_mul_f32 v4, v118, v44
    v_fma_f32 v4, v119, v45, v4
    v_fma_f32 v4, v120, v46, v4
    v_fma_f32 v4, v121, v47, v4
    v_fma_f32 v4, v122, v48, v4
    v_fma_f32 v4, v123, v49, v4
    v_fma_f32 v4, v124, v50, v4
    v_fma_f32 v4, v125, v51, v4
    v_mul_f32 v4, v4, v3
    v_cvt_pk_bf16_f32 v4, v4, v4
    v_and_b32 v20, v4, v6
    v_and_b32 v21, v4, v7
    v_and_b32 v22, v4, v8
    v_and_b32 v23, v4, v9
    s_nop 1
    v_mfma_f32_16x16x32_bf16 v[12:15], v[82:85], v[20:23], 0
    v_mul_f32 v4, v118, v52
    v_fma_f32 v4, v119, v53, v4
    v_fma_f32 v4, v120, v54, v4
    v_fma_f32 v4, v121, v55, v4
    v_fma_f32 v4, v122, v56, v4
    v_fma_f32 v4, v123, v57, v4
    v_fma_f32 v4, v124, v58, v4
    v_fma_f32 v4, v125, v59, v4
    v_mul_f32 v4, v4, v3
    v_cvt_pk_bf16_f32 v4, v4, v4
    v_and_b32 v24, v4, v6
    v_and_b32 v25, v4, v7
    v_and_b32 v26, v4, v8
    v_and_b32 v27, v4, v9
    s_nop 1
    v_mfma_f32_16x16x32_bf16 v[12:15], v[86:89], v[24:27], v[12:15]
    v_mul_f32 v4, v118, v60
    v_fma_f32 v4, v119, v61, v4
    v_fma_f32 v4, v120, v62, v4
    v_fma_f32 v4, v121, v63, v4
    v_fma_f32 v4, v122, v64, v4
    v_fma_f32 v4, v123, v65, v4
    v_fma_f32 v4, v124, v66, v4
    v_fma_f32 v4, v125, v67, v4
    v_mul_f32 v4, v4, v3
    v_cvt_pk_bf16_f32 v4, v4, v4
    v_and_b32 v20, v4, v6
    v_and_b32 v21, v4, v7
    v_and_b32 v22, v4, v8
    v_and_b32 v23, v4, v9
    s_nop 1
    v_mfma_f32_16x16x32_bf16 v[12:15], v[90:93], v[20:23], v[12:15]
    v_mul_f32 v4, v118, v68
    v_fma_f32 v4, v119, v69, v4
    v_fma_f32 v4, v120, v70, v4
    v_fma_f32 v4, v121, v71, v4
    v_fma_f32 v4, v122, v72, v4
    v_fma_f32 v4, v123, v73, v4
    v_fma_f32 v4, v124, v74, v4
    v_fma_f32 v4, v125, v75, v4
    v_mul_f32 v4, v4, v3
    v_cvt_pk_bf16_f32 v4, v4, v4
    v_and_b32 v24, v4, v6
    v_and_b32 v25, v4, v7
    v_and_b32 v26, v4, v8
    v_and_b32 v27, v4, v9
    s_nop 1
    v_mfma_f32_16x16x32_bf16 v[12:15], v[94:97], v[24:27], v[12:15]
    v_lshrrev_b32 v3, 4, v1
    s_mov_b32 s25, 0x3d372713
    s_mov_b32 s26, 0xc0135761
    v_add_f32 v136, v136, v141
    v_add_f32 v136, v136, v146
    v_add_f32 v151, v151, v156
    v_add_f32 v151, v151, v161
    v_cvt_pk_bf16_f32 v136, v136, v136
    v_and_b32 v136, 0xffff0000, v136
    v_cvt_pk_bf16_f32 v151, v151, v151
    v_and_b32 v151, 0xffff0000, v151
    v_mul_f32 v76, v136, v136
    v_mul_f32 v76, v76, v136
    v_fma_f32 v76, v76, s25, v136
    v_mul_f32 v76, s26, v76
    v_exp_f32 v76, v76
    s_nop 0
    v_add_f32 v76, 1.0, v76
    v_rcp_f32 v76, v76
    s_nop 0
    v_mul_f32 v76, v76, v136
    v_cvt_pk_bf16_f32 v76, v76, v76
    v_and_b32 v76, 0xffff0000, v76
    v_mul_f32 v76, v76, v151
    v_cvt_pk_bf16_f32 v76, v76, v76
    v_and_b32 v76, 0xffff, v76
    v_add_f32 v137, v137, v142
    v_add_f32 v137, v137, v147
    v_add_f32 v152, v152, v157
    v_add_f32 v152, v152, v162
    v_cvt_pk_bf16_f32 v137, v137, v137
    v_and_b32 v137, 0xffff0000, v137
    v_cvt_pk_bf16_f32 v152, v152, v152
    v_and_b32 v152, 0xffff0000, v152
    v_mul_f32 v77, v137, v137
    v_mul_f32 v77, v77, v137
    v_fma_f32 v77, v77, s25, v137
    v_mul_f32 v77, s26, v77
    v_exp_f32 v77, v77
    s_nop 0
    v_add_f32 v77, 1.0, v77
    v_rcp_f32 v77, v77
    s_nop 0
    v_mul_f32 v77, v77, v137
    v_cvt_pk_bf16_f32 v77, v77, v77
    v_and_b32 v77, 0xffff0000, v77
    v_mul_f32 v77, v77, v152
    v_cvt_pk_bf16_f32 v77, v77, v77
    v_and_b32 v77, 0xffff, v77
    v_add_f32 v138, v138, v143
    v_add_f32 v138, v138, v148
    v_add_f32 v153, v153, v158
    v_add_f32 v153, v153, v163
    v_cvt_pk_bf16_f32 v138, v138, v138
    v_and_b32 v138, 0xffff0000, v138
    v_cvt_pk_bf16_f32 v153, v153, v153
    v_and_b32 v153, 0xffff0000, v153
    v_mul_f32 v78, v138, v138
    v_mul_f32 v78, v78, v138
    v_fma_f32 v78, v78, s25, v138
    v_mul_f32 v78, s26, v78
    v_exp_f32 v78, v78
    s_nop 0
    v_add_f32 v78, 1.0, v78
    v_rcp_f32 v78, v78
    s_nop 0
    v_mul_f32 v78, v78, v138
    v_cvt_pk_bf16_f32 v78, v78, v78
    v_and_b32 v78, 0xffff0000, v78
    v_mul_f32 v78, v78, v153
    v_cvt_pk_bf16_f32 v78, v78, v78
    v_and_b32 v78, 0xffff, v78
    v_add_f32 v139, v139, v144
    v_add_f32 v139, v139, v149
    v_add_f32 v154, v154, v159
    v_add_f32 v154, v154, v164
    v_cvt_pk_bf16_f32 v139, v139, v139
    v_and_b32 v139, 0xffff0000, v139
    v_cvt_pk_bf16_f32 v154, v154, v154
    v_and_b32 v154, 0xffff0000, v154
    v_mul_f32 v79, v139, v139
    v_mul_f32 v79, v79, v139
    v_fma_f32 v79, v79, s25, v139
    v_mul_f32 v79, s26, v79
    v_exp_f32 v79, v79
    s_nop 0
    v_add_f32 v79, 1.0, v79
    v_rcp_f32 v79, v79
    s_nop 0
    v_mul_f32 v79, v79, v139
    v_cvt_pk_bf16_f32 v79, v79, v79
    v_and_b32 v79, 0xffff0000, v79
    v_mul_f32 v79, v79, v154
    v_cvt_pk_bf16_f32 v79, v79, v79
    v_and_b32 v79, 0xffff, v79
    v_add_f32 v140, v140, v145
    v_add_f32 v140, v140, v150
    v_add_f32 v155, v155, v160
    v_add_f32 v155, v155, v165
    v_cvt_pk_bf16_f32 v140, v140, v140
    v_and_b32 v140, 0xffff0000, v140
    v_cvt_pk_bf16_f32 v155, v155, v155
    v_and_b32 v155, 0xffff0000, v155
    v_mul_f32 v80, v140, v140
    v_mul_f32 v80, v80, v140
    v_fma_f32 v80, v80, s25, v140
    v_mul_f32 v80, s26, v80
    v_exp_f32 v80, v80
    s_nop 0
    v_add_f32 v80, 1.0, v80
    v_rcp_f32 v80, v80
    s_nop 0
    v_mul_f32 v80, v80, v140
    v_cvt_pk_bf16_f32 v80, v80, v80
    v_and_b32 v80, 0xffff0000, v80
    v_mul_f32 v80, v80, v155
    v_cvt_pk_bf16_f32 v80, v80, v80
    v_and_b32 v80, 0xffff, v80
    v_lshl_or_b32 v4, v76, 16, v76
    v_and_b32 v20, v4, v6
    v_and_b32 v21, v4, v7
    v_and_b32 v22, v4, v8
    v_and_b32 v23, v4, v9
    s_nop 1
    v_mfma_f32_16x16x32_bf16 v[16:19], v[98:101], v[20:23], 0
    v_lshl_or_b32 v4, v77, 16, v77
    v_and_b32 v24, v4, v6
    v_and_b32 v25, v4, v7
    v_and_b32 v26, v4, v8
    v_and_b32 v27, v4, v9
    s_nop 1
    v_mfma_f32_16x16x32_bf16 v[16:19], v[102:105], v[24:27], v[16:19]
    v_lshl_or_b32 v4, v78, 16, v78
    v_and_b32 v20, v4, v6
    v_and_b32 v21, v4, v7
    v_and_b32 v22, v4, v8
    v_and_b32 v23, v4, v9
    s_nop 1
    v_mfma_f32_16x16x32_bf16 v[16:19], v[106:109], v[20:23], v[16:19]
    v_lshl_or_b32 v4, v79, 16, v79
    v_and_b32 v24, v4, v6
    v_and_b32 v25, v4, v7
    v_and_b32 v26, v4, v8
    v_and_b32 v27, v4, v9
    s_nop 1
    v_mfma_f32_16x16x32_bf16 v[16:19], v[110:113], v[24:27], v[16:19]
    v_lshl_or_b32 v4, v80, 16, v80
    v_cmp_gt_u32 vcc, 2, v3
    s_nop 1
    v_cndmask_b32 v4, 0, v4, vcc
    v_and_b32 v20, v4, v6
    v_and_b32 v21, v4, v7
    v_and_b32 v22, v4, v8
    v_and_b32 v23, v4, v9
    s_nop 1
    v_mfma_f32_16x16x32_bf16 v[16:19], v[114:117], v[20:23], v[16:19]
    s_nop 7
    v_sub_f32 v2, 1.0, v126
    v_mul_f32 v12, v12, v126
    v_fma_f32 v12, v16, v2, v12
    v_mul_f32 v13, v13, v126
    v_fma_f32 v13, v17, v2, v13
    v_mul_f32 v14, v14, v126
    v_fma_f32 v14, v18, v2, v14
    v_mul_f32 v15, v15, v126
    v_fma_f32 v15, v19, v2, v15
    s_and_b32 s25, s2, 7
    s_mul_i32 s25, s25, 5120
    s_lshl_b32 s26, s24, 10
    s_add_u32 s25, s25, s26
    s_add_u32 s25, s25, 0x20000
    v_lshlrev_b32 v2, 2, v1
    buffer_atomic_add_f32 v12, v2, s[4:7], s25 offen offset:0
    buffer_atomic_add_f32 v13, v2, s[4:7], s25 offen offset:256
    buffer_atomic_add_f32 v14, v2, s[4:7], s25 offen offset:512
    buffer_atomic_add_f32 v15, v2, s[4:7], s25 offen offset:768
    s_waitcnt vmcnt(0)
    s_barrier
    v_mov_b32 v3, 1
    v_mov_b32 v4, 0
    s_cmp_lg_u32 s24, 0
    s_cbranch_scc1 gmix_c_kernel_wait
    s_mov_b64 exec, 1
    buffer_atomic_add v3, v4, s[20:23], 0 offen sc0
    s_waitcnt vmcnt(0)
    ds_write_b32 v4, v3
    s_waitcnt lgkmcnt(0)
    s_mov_b64 exec, -1
gmix_c_kernel_wait:
    s_barrier
    v_mov_b32 v4, 0
    ds_read_b32 v3, v4
    s_waitcnt lgkmcnt(0)
    v_readfirstlane_b32 s25, v3
    s_cmp_lg_u32 s25, 255
    s_cbranch_scc1 gmix_c_kernel_end
    s_lshl_b32 s26, s24, 10
    s_add_u32 s26, s26, 0x20000
    buffer_load_dword v44, v2, s[4:7], s26 offen offset:0 sc0 sc1
    buffer_load_dword v45, v2, s[4:7], s26 offen offset:256 sc0 sc1
    buffer_load_dword v46, v2, s[4:7], s26 offen offset:512 sc0 sc1
    buffer_load_dword v47, v2, s[4:7], s26 offen offset:768 sc0 sc1
    s_add_u32 s26, s26, 5120
    buffer_load_dword v48, v2, s[4:7], s26 offen offset:0 sc0 sc1
    buffer_load_dword v49, v2, s[4:7], s26 offen offset:256 sc0 sc1
    buffer_load_dword v50, v2, s[4:7], s26 offen offset:512 sc0 sc1
    buffer_load_dword v51, v2, s[4:7], s26 offen offset:768 sc0 sc1
    s_add_u32 s26, s26, 5120
    buffer_load_dword v52, v2, s[4:7], s26 offen offset:0 sc0 sc1
    buffer_load_dword v53, v2, s[4:7], s26 offen offset:256 sc0 sc1
    buffer_load_dword v54, v2, s[4:7], s26 offen offset:512 sc0 sc1
    buffer_load_dword v55, v2, s[4:7], s26 offen offset:768 sc0 sc1
    s_add_u32 s26, s26, 5120
    buffer_load_dword v56, v2, s[4:7], s26 offen offset:0 sc0 sc1
    buffer_load_dword v57, v2, s[4:7], s26 offen offset:256 sc0 sc1
    buffer_load_dword v58, v2, s[4:7], s26 offen offset:512 sc0 sc1
    buffer_load_dword v59, v2, s[4:7], s26 offen offset:768 sc0 sc1
    s_add_u32 s26, s26, 5120
    buffer_load_dword v60, v2, s[4:7], s26 offen offset:0 sc0 sc1
    buffer_load_dword v61, v2, s[4:7], s26 offen offset:256 sc0 sc1
    buffer_load_dword v62, v2, s[4:7], s26 offen offset:512 sc0 sc1
    buffer_load_dword v63, v2, s[4:7], s26 offen offset:768 sc0 sc1
    s_add_u32 s26, s26, 5120
    buffer_load_dword v64, v2, s[4:7], s26 offen offset:0 sc0 sc1
    buffer_load_dword v65, v2, s[4:7], s26 offen offset:256 sc0 sc1
    buffer_load_dword v66, v2, s[4:7], s26 offen offset:512 sc0 sc1
    buffer_load_dword v67, v2, s[4:7], s26 offen offset:768 sc0 sc1
    s_add_u32 s26, s26, 5120
    buffer_load_dword v68, v2, s[4:7], s26 offen offset:0 sc0 sc1
    buffer_load_dword v69, v2, s[4:7], s26 offen offset:256 sc0 sc1
    buffer_load_dword v70, v2, s[4:7], s26 offen offset:512 sc0 sc1
    buffer_load_dword v71, v2, s[4:7], s26 offen offset:768 sc0 sc1
    s_add_u32 s26, s26, 5120
    buffer_load_dword v72, v2, s[4:7], s26 offen offset:0 sc0 sc1
    buffer_load_dword v73, v2, s[4:7], s26 offen offset:256 sc0 sc1
    buffer_load_dword v74, v2, s[4:7], s26 offen offset:512 sc0 sc1
    buffer_load_dword v75, v2, s[4:7], s26 offen offset:768 sc0 sc1
    s_add_u32 s26, s26, 5120
    s_waitcnt vmcnt(0)
    v_add_f32 v44, v44, v48
    v_add_f32 v44, v44, v52
    v_add_f32 v44, v44, v56
    v_add_f32 v44, v44, v60
    v_add_f32 v44, v44, v64
    v_add_f32 v44, v44, v68
    v_add_f32 v44, v44, v72
    v_add_f32 v45, v45, v49
    v_add_f32 v45, v45, v53
    v_add_f32 v45, v45, v57
    v_add_f32 v45, v45, v61
    v_add_f32 v45, v45, v65
    v_add_f32 v45, v45, v69
    v_add_f32 v45, v45, v73
    v_add_f32 v46, v46, v50
    v_add_f32 v46, v46, v54
    v_add_f32 v46, v46, v58
    v_add_f32 v46, v46, v62
    v_add_f32 v46, v46, v66
    v_add_f32 v46, v46, v70
    v_add_f32 v46, v46, v74
    v_add_f32 v47, v47, v51
    v_add_f32 v47, v47, v55
    v_add_f32 v47, v47, v59
    v_add_f32 v47, v47, v63
    v_add_f32 v47, v47, v67
    v_add_f32 v47, v47, v71
    v_add_f32 v47, v47, v75
    v_lshrrev_b32 v2, 4, v1
    v_lshlrev_b32 v2, 5, v2
    v_and_b32 v3, 7, v1
    v_add_u32 v2, v2, v3
    s_lshl_b32 s25, s24, 7
    v_add_u32 v2, s25, v2
    v_bfe_u32 v3, v1, 3, 1
    v_mul_u32_u24 v3, 576, v3
    v_add_u32 v4, 0, v2
    v_cmp_gt_u32 vcc, 576, v4
    v_add_u32 v4, v4, v3
    v_lshlrev_b32 v4, 1, v4
    v_mov_b32 v128, 0x7ffffff0
    v_cndmask_b32 v4, v128, v4, vcc
    v_cvt_pk_bf16_f32 v129, v44, v44
    buffer_store_short v129, v4, s[16:19], 0 offen
    v_add_u32 v4, 8, v2
    v_cmp_gt_u32 vcc, 576, v4
    v_add_u32 v4, v4, v3
    v_lshlrev_b32 v4, 1, v4
    v_mov_b32 v128, 0x7ffffff0
    v_cndmask_b32 v4, v128, v4, vcc
    v_cvt_pk_bf16_f32 v129, v45, v45
    buffer_store_short v129, v4, s[16:19], 0 offen
    v_add_u32 v4, 16, v2
    v_cmp_gt_u32 vcc, 576, v4
    v_add_u32 v4, v4, v3
    v_lshlrev_b32 v4, 1, v4
    v_mov_b32 v128, 0x7ffffff0
    v_cndmask_b32 v4, v128, v4, vcc
    v_cvt_pk_bf16_f32 v129, v46, v46
    buffer_store_short v129, v4, s[16:19], 0 offen
    v_add_u32 v4, 24, v2
    v_cmp_gt_u32 vcc, 576, v4
    v_add_u32 v4, v4, v3
    v_lshlrev_b32 v4, 1, v4
    v_mov_b32 v128, 0x7ffffff0
    v_cndmask_b32 v4, v128, v4, vcc
    v_cvt_pk_bf16_f32 v129, v47, v47
    buffer_store_short v129, v4, s[16:19], 0 offen
    s_waitcnt vmcnt(0)
gmix_c_kernel_end:
    s_endpgm
.section .rodata,"a"
.p2align 6
.amdhsa_kernel gmix_a_kernel
  .amdhsa_next_free_vgpr 86
  .amdhsa_next_free_sgpr 36
  .amdhsa_accum_offset 88
  .amdhsa_group_segment_fixed_size 0
  .amdhsa_kernarg_size 104
  .amdhsa_user_sgpr_count 2
  .amdhsa_user_sgpr_kernarg_segment_ptr 1
  .amdhsa_system_sgpr_workgroup_id_x 1
.end_amdhsa_kernel
.p2align 6
.amdhsa_kernel gmix_b_kernel
  .amdhsa_next_free_vgpr 188
  .amdhsa_next_free_sgpr 32
  .amdhsa_accum_offset 188
  .amdhsa_group_segment_fixed_size 0
  .amdhsa_kernarg_size 104
  .amdhsa_user_sgpr_count 2
  .amdhsa_user_sgpr_kernarg_segment_ptr 1
  .amdhsa_system_sgpr_workgroup_id_x 1
.end_amdhsa_kernel
.p2align 6
.amdhsa_kernel gmix_c_kernel
  .amdhsa_next_free_vgpr 168
  .amdhsa_next_free_sgpr 40
  .amdhsa_accum_offset 168
  .amdhsa_group_segment_fixed_size 0
  .amdhsa_kernarg_size 104
  .amdhsa_user_sgpr_count 2
  .amdhsa_user_sgpr_kernarg_segment_ptr 1
  .amdhsa_system_sgpr_workgroup_id_x 1
.end_amdhsa_kernel
```
